```python
import torch

def _softmax(x, axis=-1):
    return torch.softmax(x, dim=axis)
def _gelu(x):
    return torch.nn.functional.gelu(x, approximate="tanh")
def _silu(x):
    return torch.nn.functional.silu(x)
def _sigmoid(x):
    return torch.sigmoid(x)
def _layernorm(x, axis=-1, eps=1e-5):
    m = x.mean(dim=axis, keepdim=True)
    v = x.var(dim=axis, keepdim=True, unbiased=False)
    return (x - m) / torch.sqrt(v + eps)
def _scatter_add(tgt, idx, src, axis=0):
    return tgt.clone().index_add_(axis, idx, src)
def _segment_sum(src, seg, n):
    out = torch.zeros((n,) + src.shape[1:], dtype=src.dtype)
    return out.index_add_(0, seg, src)
def _pad(x, pw):
    flat = tuple(v for pair in reversed(pw) for v in pair)
    return torch.nn.functional.pad(x, flat)

kernel_name = 'sequential_preLN__linear_kernel_hedgehog__swiglu_ffn__prompt'

def setup_inputs():

    _w = (lambda a: (lambda t: t.to(torch.bfloat16) if t.is_floating_point() else t)(torch.as_tensor(a)))
    def _A_setup():
        B, S, D, H = 1, 2048, 448, 16
        Dh = D // H
        return {
            "x": _w((lambda *s: torch.randn(*s, dtype=torch.bfloat16) * 0.05)(B, S, D)),
            "wqkv": _w((lambda *s: torch.randn(*s, dtype=torch.bfloat16) * 0.2)(D, 3 * D)),
            "w_phi": _w((lambda *s: torch.randn(*s, dtype=torch.bfloat16) * 0.2)(H, Dh, Dh) * (Dh ** -0.5)),
            "wo": _w((lambda *s: torch.randn(*s, dtype=torch.bfloat16) * 0.05)(D, D)),
        }
    _A_in = _A_setup()

    def _B_setup():
        B, S, D, F = 1, 2048, 448, 1792
        return {
            "x": _w((lambda *s: torch.randn(*s, dtype=torch.bfloat16) * 0.05)(B, S, D)),
            "w_gate": _w((lambda *s: torch.randn(*s, dtype=torch.bfloat16) * 0.05)(D, F)),
            "w_up": _w((lambda *s: torch.randn(*s, dtype=torch.bfloat16) * 0.05)(D, F)),
            "w_down": _w((lambda *s: torch.randn(*s, dtype=torch.bfloat16) * 0.05)(F, D)),
        }
    _B_in = _B_setup()

    return {
        "A_x": _A_in["x"],
        "A_wqkv": _A_in["wqkv"],
        "A_w_phi": _A_in["w_phi"],
        "A_wo": _A_in["wo"],
        "B_x": _B_in["x"],
        "B_w_gate": _B_in["w_gate"],
        "B_w_up": _B_in["w_up"],
        "B_w_down": _B_in["w_down"],
    }

def reference(A_x, A_wqkv, A_w_phi, A_wo, B_x, B_w_gate, B_w_up, B_w_down):
    def _A_ref(x, wqkv, w_phi, wo):
        B, S, D = x.shape
        H = 16; Dh = D // H
        qkv = (lambda x, *d: x.permute(*d))((x @ wqkv).reshape(B, S, 3, H, Dh), 2, 0, 3, 1, 4)
        q, k, v = qkv[0], qkv[1], qkv[2]
        pq = torch.einsum("bhsd,hdf->bhsf", q, w_phi)
        pk = torch.einsum("bhsd,hdf->bhsf", k, w_phi)
        phi_q = torch.concatenate([_softmax(pq, axis=-1), _softmax(-pq, axis=-1)], axis=-1)
        phi_k = torch.concatenate([_softmax(pk, axis=-1), _softmax(-pk, axis=-1)], axis=-1)
        kv = torch.einsum("bhsf,bhsd->bhfd", phi_k, v)
        z  = torch.einsum("bhsf->bhf", phi_k)
        num = torch.einsum("bhqf,bhfd->bhqd", phi_q, kv)
        den = torch.einsum("bhqf,bhf->bhq", phi_q, z)[..., None] + 1e-6
        o = num / den
        return (lambda x, *d: x.permute(*d))(o, 0, 2, 1, 3).reshape(B, S, D) @ wo

    def _B_ref(x, w_gate, w_up, w_down):
        g = _silu(x @ w_gate)
        u = x @ w_up
        return (g * u) @ w_down

    x = A_x
    h = x + _A_ref(_layernorm(x, axis=-1), A_wqkv, A_w_phi, A_wo)
    h2 = h + _B_ref(_layernorm(h, axis=-1), B_w_gate, B_w_up, B_w_down)
    return h2
```

```asm
; @launch grid=(256,1,1) block=(256,1,1) lds=163840
.amdgcn_target "amdgcn-amd-amdhsa--gfx950"
.text
.p2align 12
.fill 512, 4, 0xbf800000
.globl sequential_preLN__linear_kernel_hedgehog__swiglu_ffn__prompt_kernel
.p2align 8
.type sequential_preLN__linear_kernel_hedgehog__swiglu_ffn__prompt_kernel,@function
sequential_preLN__linear_kernel_hedgehog__swiglu_ffn__prompt_kernel:
    s_load_dwordx16 s[4:19], s[0:1], 0
    s_load_dwordx4 s[20:23], s[0:1], 64
    s_load_dwordx2 s[24:25], s[0:1], 80
    s_lshr_b32 s59, s2, 6
    s_cmp_ge_u32 s59, 4
    s_cbranch_scc1 L_end
    v_lshrrev_b32 v1, 6, v0
    s_getpc_b64 s[92:93]
L_pc:
    s_and_b32 s26, s2, 0xf8
    v_lshrrev_b32 v2, 5, v0
    v_add_u32 v2, s26, v2
    v_lshlrev_b32 v2, 7, v2
    v_min_u32 v2, L_end-L_pc, v2
    global_load_dword v15, v2, s[92:93]
    v_and_b32 v0, 63, v0
    v_readfirstlane_b32 s3, v1
    s_and_b32 s60, s2, 7
    s_bfe_u32 s76, s2, 0x30003
    s_lshr_b32 s57, s60, 1
    s_lshl2_add_u32 s57, s57, s59
    s_lshl1_add_u32 s58, s59, s76
    s_sub_u32 s56, s58, 7
    s_min_u32 s58, s58, s56
    s_lshl2_add_u32 s61, s57, s3
    s_mulk_i32 s61, 28672
    s_mul_i32 m0, s3, 28672
    s_lshl_b32 s62, s58, 7
    s_add_u32 s62, s62, s61
    v_lshrrev_b32 v6, 3, v0
    v_and_b32 v7, 7, v0
    v_lshrrev_b32 v8, 4, v0
    v_xor_b32 v7, v7, v8
    v_lshlrev_b32 v7, 4, v7
    v_mul_u32_u24 v6, 896, v6
    v_add_u32 v2, v6, v7
    v_xor_b32 v3, 64, v2
    v_add_u32 v3, 6144, v3
    v_add_u32 v4, 12288, v2
    v_add_u32 v5, 12288, v3
    s_lshl_b32 s30, 7, 18
    s_mov_b32 s31, 0x20000
    s_waitcnt lgkmcnt(0)
    s_mov_b64 s[28:29], s[4:5]
    buffer_load_dwordx4 v2, s[28:31], s62 offen offset:0  lds
    buffer_load_dwordx4 v3, s[28:31], s62 offen offset:1024  lds
    buffer_load_dwordx4 v4, s[28:31], s62 offen offset:2048  lds
    buffer_load_dwordx4 v5, s[28:31], s62 offen offset:3072  lds
    s_mov_b32 s72, m0
    s_add_u32 s63, s61, 896
    v_lshlrev_b32 v1, 4, v0
    s_add_u32 m0, s72, 4096
    s_add_u32 s62, s62, 128
    s_cmp_eq_u32 s62, s63
    s_cselect_b32 s62, s61, s62
    buffer_load_dwordx4 v2, s[28:31], s62 offen offset:0  lds
    s_mov_b64 s[32:33], s[6:7]
    s_mov_b32 s34, 1204224
    s_mov_b32 s35, 0x20000
    s_mov_b64 s[36:37], s[8:9]
    s_mov_b32 s38, 25088
    s_mov_b32 s39, 0x20000
    s_mov_b64 s[40:41], s[24:25]
    s_mov_b32 s42, 67108864
    s_mov_b32 s43, 0x20000
    v_mov_b32 v240, 0
    v_mov_b32 v241, 0
    v_mov_b32 v242, 0
    buffer_load_dwordx4 v3, s[28:31], s62 offen offset:1024  lds
    v_mov_b32 v243, 0
    s_lshl_b32 s26, s2, 10
    s_cmp_lt_u32 s2, 44
    s_cselect_b32 s90, s3, 0
    s_cmp_eq_u32 s90, 3
    s_cbranch_scc0 L_init_1
    buffer_store_dwordx4 v[240:243], v1, s[40:43], s26 offen sc1
L_init_1:
    s_and_b32 s56, s60, 1
    s_lshl_b32 s56, s56, 3
    s_add_u32 s56, s56, s76
    s_lshl_b32 s71, s3, 10
    buffer_load_dwordx4 v4, s[28:31], s62 offen offset:2048  lds
    s_mul_i32 s26, s3, 43008
    s_mul_i32 s27, s56, 56
    s_add_u32 s26, s26, s27
    s_add_u32 s27, s26, 1204224
    s_mul_i32 s64, s58, 172032
    s_add_u32 s64, s64, s26
    s_add_u32 s65, s64, 172032
    s_cmp_eq_u32 s65, s27
    s_cselect_b32 s65, s26, s65
    s_add_u32 s66, s65, 172032
    s_cmp_eq_u32 s66, s27
    s_cselect_b32 s66, s26, s66
    buffer_load_dwordx4 v5, s[28:31], s62 offen offset:3072  lds
    s_add_u32 s67, s66, 172032
    s_cmp_eq_u32 s67, s27
    s_cselect_b32 s67, s26, s67
    s_add_u32 s68, s67, 172032
    s_cmp_eq_u32 s68, s27
    s_cselect_b32 s68, s26, s68
    s_add_u32 s69, s68, 172032
    s_cmp_eq_u32 s69, s27
    s_cselect_b32 s69, s26, s69
    s_add_u32 s70, s69, 172032
    s_cmp_eq_u32 s70, s27
    s_cselect_b32 s70, s26, s70
    s_add_u32 m0, s72, 8192
    s_add_u32 s62, s62, 128
    s_cmp_eq_u32 s62, s63
    s_cselect_b32 s62, s61, s62
    buffer_load_dwordx4 v2, s[28:31], s62 offen offset:0  lds
    s_mov_b32 s83, 0x3f803f80
    s_mov_b32 s81, 0x00003f80
    s_mov_b32 s84, 0x3fb8aa3b
    v_and_b32 v6, 31, v0
    v_lshrrev_b32 v7, 5, v0
    v_bfe_u32 v8, v0, 1, 3
    v_xor_b32 v8, v8, v7
    v_lshlrev_b32 v8, 4, v8
    v_lshl_add_u32 v6, v6, 7, v8
    v_add_u32 v6, s72, v6
    v_add_u32 v13, -1, v7
    v_and_b32 v14, 1.0, v13
    buffer_load_dwordx4 v3, s[28:31], s62 offen offset:1024  lds
    v_lshrrev_b32 v10, 2, v0
    v_mul_u32_u24 v10, 2688, v10
    v_and_b32 v8, 3, v0
    v_lshlrev_b32 v9, 4, v8
    v_min_u32 v9, 40, v9
    v_add_u32 v10, v10, v9
    v_bfe_u32 v9, v0, 4, 1
    v_lshl_add_u32 v8, v9, 2, v8
    v_bfe_u32 v9, v0, 2, 2
    v_lshl_add_u32 v244, v7, 2, v9
    v_mul_u32_u24 v244, 56, v244
    v_min_u32 v245, 6, v8
    buffer_load_dwordx4 v4, s[28:31], s62 offen offset:2048  lds
    v_lshl_add_u32 v244, v245, 3, v244
    v_add_u32 v244, 143360, v244
    v_lshl_add_u32 v9, v7, 3, v9
    v_xor_b32 v245, 1, v8
    v_cmp_le_u32 vcc, 6, v8
    s_nop 1
    v_cndmask_b32 v8, v8, v245, vcc
    v_lshlrev_b32 v8, 3, v8
    v_lshl_add_u32 v11, v9, 6, v8
    v_add_u32 v12, 114688, v11
    v_xor_b32 v7, 32, v6
    v_xor_b32 v8, 64, v6
    v_xor_b32 v9, 96, v6
    s_mov_b32 s99, 1
    s_lshl_b32 s98, s3, 8
    s_add_u32 s98, s98, s2
    s_sub_u32 s98, s98, 320
    s_cmp_lt_u32 s98, 5
    s_cbranch_scc0 L_init_2
    s_and_b32 s13, s98, 1
    s_lshl_b32 s13, s13, 5
    s_add_u32 s13, s13, s98
    s_lshl_b32 s13, s13, 8
    s_xor_b32 s91, s13, 8192
    s_atomic_swap s99, s[24:25], s13 offset:49152
    s_atomic_swap s99, s[24:25], s91 offset:49152
L_init_2:
    s_and_b32 s80, s60, 1
    s_add_u32 s76, s76, s80
    s_and_b32 s76, s76, 7
    s_xor_b32 s85, s76, 1
    s_sub_u32 s85, s85, s80
    s_and_b32 s85, s85, 7
    s_lshl_b32 s12, s80, 3
    s_add_u32 s85, s85, s12
    s_lshl_b32 s12, s76, 2
    s_lshl2_add_u32 s73, s60, s59
    s_mul_i32 s101, s73, 57344
    s_lshr_b32 s13, s3, 1
    s_lshl1_add_u32 s73, s73, s13
    s_lshr_b32 s13, 0x6e543210, s12
    s_and_b32 s79, s13, 7
    s_bfe_u32 s78, s13, 0x10003
    s_mul_i32 s77, s80, 7
    s_add_u32 s77, s77, s79
    s_and_b32 s12, s3, 1
    s_lshl1_add_u32 s75, s79, s12
    s_sub_u32 s58, s78, 1
    s_lshl_b32 s86, s56, 7
    s_mul_i32 s100, s3, 7168
    s_lshl_b32 s12, s79, 7
    s_add_u32 s101, s101, s12
    s_add_u32 s101, s101, s100
    s_mov_b64 s[44:45], s[10:11]
    s_mov_b32 s46, 401408
    s_mov_b32 s47, 0x20000
    s_mov_b64 s[48:49], s[14:15]
    s_mov_b32 s50, 1605632
    s_mov_b32 s51, 0x20000
    s_mov_b64 s[52:53], s[16:17]
    s_mov_b32 s54, 1605632
    s_mov_b32 s55, 0x20000
    s_mul_i32 s60, s59, 1
    s_mul_i32 s12, s3, 25088
    s_lshl_b32 s13, s79, 7
    s_add_u32 s12, s12, s13
    s_and_b32 s13, s60, 1
    s_mul_i32 s13, s13, 200704
    buffer_load_dwordx4 v5, s[28:31], s62 offen offset:3072  lds
    s_mov_b32 s82, 1
    s_mov_b64 exec, 0
    s_cmp_eq_u32 s3, 0
    s_cbranch_scc1 L_pad1
    s_cmp_eq_u32 s3, 1
    s_cbranch_scc1 L_pad2
    s_cmp_eq_u32 s3, 2
    s_cbranch_scc1 L_pad3
    s_branch L_pad4
.p2align 12
L_body:
    s_cmp_eq_u32 s82, 1
    s_cbranch_scc0 L_end
    s_mov_b32 s82, 0
    s_mov_b64 exec, -1
    s_waitcnt vmcnt(8)
    ds_read_b128 v[16:19], v6 offset:0
    ds_read_b128 v[20:23], v7 offset:0
    ds_read_b128 v[24:27], v8 offset:0
    ds_read_b128 v[28:31], v9 offset:0
    s_add_u32 m0, s72, 12288
    s_add_u32 s62, s62, 128
    s_cmp_eq_u32 s62, s63
    s_cselect_b32 s62, s61, s62
    buffer_load_dwordx4 v2, s[28:31], s62 offen offset:0  lds
    buffer_load_dwordx4 v3, s[28:31], s62 offen offset:1024  lds
    buffer_load_dwordx4 v4, s[28:31], s62 offen offset:2048  lds
    buffer_load_dwordx4 v5, s[28:31], s62 offen offset:3072  lds
    s_add_u32 s4, s12, s13
    s_sub_u32 s12, s12, s13
    s_add_u32 s5, s12, 200704
    s_mul_i32 s12, s3, 100352
    s_lshl_b32 s13, s77, 8
    s_add_u32 s12, s12, s13
    s_add_u32 s13, s60, 0
    s_and_b32 s13, s13, 3
    s_mul_i32 s13, s13, 401408
    s_add_u32 s8, s13, s12
    s_add_u32 s13, s60, 1
    s_and_b32 s13, s13, 3
    s_mul_i32 s13, s13, 401408
    s_add_u32 s9, s13, s12
    s_add_u32 s13, s60, 2
    s_and_b32 s13, s13, 3
    s_mul_i32 s13, s13, 401408
    s_add_u32 s10, s13, s12
    s_add_u32 s13, s60, 3
    s_and_b32 s13, s13, 3
    s_mul_i32 s13, s13, 401408
    s_add_u32 s11, s13, s12
    s_add_u32 s12, s76, 1
    s_lshr_b32 s12, s12, 1
    s_lshr_b32 s13, s73, 1
    s_mul_i32 s13, s13, 5
    s_add_u32 s12, s12, s13
    s_mul_i32 s13, s3, 160
    s_add_u32 s12, s12, s13
    s_lshr_b32 s13, 0x5580, s76
    s_and_b32 s13, s13, 128
    s_cmp_lt_u32 s12, 245
    s_cselect_b32 s13, s13, 0
    v_mul_u32_u24 v159, s13, v0
    s_min_u32 s12, s12, 244
    s_sub_u32 s13, s12, 49
    s_cmp_ge_u32 s12, 49
    s_cselect_b64 s[88:89], s[52:53], s[44:45]
    s_cselect_b32 s12, s13, s12
    s_lshl_b32 s12, s12, 13
    v_add_u32 v159, s12, v159
    s_waitcnt vmcnt(8)
    ds_read_b128 v[32:35], v6 offset:4096
    ds_read_b128 v[36:39], v7 offset:4096
    ds_read_b128 v[40:43], v8 offset:4096
    ds_read_b128 v[44:47], v9 offset:4096
    s_add_u32 m0, s72, 16384
    s_add_u32 s62, s62, 128
    s_cmp_eq_u32 s62, s63
    s_cselect_b32 s62, s61, s62
    buffer_load_dwordx4 v2, s[28:31], s62 offen offset:0  lds
    s_waitcnt lgkmcnt(4)
    v_dot2c_f32_bf16 v240, s83, v16
    v_dot2c_f32_bf16 v241, v16, v16
    v_dot2c_f32_bf16 v240, s83, v17
    v_dot2c_f32_bf16 v241, v17, v17
    v_dot2c_f32_bf16 v240, s83, v18
    v_dot2c_f32_bf16 v241, v18, v18
    v_dot2c_f32_bf16 v240, s83, v19
    v_dot2c_f32_bf16 v241, v19, v19
    buffer_load_dwordx4 v3, s[28:31], s62 offen offset:1024  lds
    v_dot2c_f32_bf16 v240, s83, v20
    v_dot2c_f32_bf16 v241, v20, v20
    v_dot2c_f32_bf16 v240, s83, v21
    v_dot2c_f32_bf16 v241, v21, v21
    v_dot2c_f32_bf16 v240, s83, v22
    v_dot2c_f32_bf16 v241, v22, v22
    v_dot2c_f32_bf16 v240, s83, v23
    v_dot2c_f32_bf16 v241, v23, v23
    buffer_load_dwordx4 v4, s[28:31], s62 offen offset:2048  lds
    v_dot2c_f32_bf16 v240, s83, v24
    v_dot2c_f32_bf16 v241, v24, v24
    v_dot2c_f32_bf16 v240, s83, v25
    v_dot2c_f32_bf16 v241, v25, v25
    v_dot2c_f32_bf16 v240, s83, v26
    v_dot2c_f32_bf16 v241, v26, v26
    v_dot2c_f32_bf16 v240, s83, v27
    v_dot2c_f32_bf16 v241, v27, v27
    buffer_load_dwordx4 v5, s[28:31], s62 offen offset:3072  lds
    v_dot2c_f32_bf16 v240, s83, v28
    v_dot2c_f32_bf16 v241, v28, v28
    v_dot2c_f32_bf16 v240, s83, v29
    v_dot2c_f32_bf16 v241, v29, v29
    v_dot2c_f32_bf16 v240, s83, v30
    v_dot2c_f32_bf16 v241, v30, v30
    v_dot2c_f32_bf16 v240, s83, v31
    v_dot2c_f32_bf16 v241, v31, v31
    s_waitcnt vmcnt(8)
    ds_read_b128 v[48:51], v6 offset:8192
    ds_read_b128 v[52:55], v7 offset:8192
    ds_read_b128 v[56:59], v8 offset:8192
    ds_read_b128 v[60:63], v9 offset:8192
    s_add_u32 m0, s72, 20480
    s_add_u32 s62, s62, 128
    s_cmp_eq_u32 s62, s63
    s_cselect_b32 s62, s61, s62
    buffer_load_dwordx4 v2, s[28:31], s62 offen offset:0  lds
    s_waitcnt lgkmcnt(4)
    v_dot2c_f32_bf16 v240, s83, v32
    v_dot2c_f32_bf16 v241, v32, v32
    v_dot2c_f32_bf16 v240, s83, v33
    v_dot2c_f32_bf16 v241, v33, v33
    v_dot2c_f32_bf16 v240, s83, v34
    v_dot2c_f32_bf16 v241, v34, v34
    v_dot2c_f32_bf16 v240, s83, v35
    v_dot2c_f32_bf16 v241, v35, v35
    buffer_load_dwordx4 v3, s[28:31], s62 offen offset:1024  lds
    v_dot2c_f32_bf16 v240, s83, v36
    v_dot2c_f32_bf16 v241, v36, v36
    v_dot2c_f32_bf16 v240, s83, v37
    v_dot2c_f32_bf16 v241, v37, v37
    v_dot2c_f32_bf16 v240, s83, v38
    v_dot2c_f32_bf16 v241, v38, v38
    v_dot2c_f32_bf16 v240, s83, v39
    v_dot2c_f32_bf16 v241, v39, v39
    buffer_load_dwordx4 v4, s[28:31], s62 offen offset:2048  lds
    v_dot2c_f32_bf16 v240, s83, v40
    v_dot2c_f32_bf16 v241, v40, v40
    v_dot2c_f32_bf16 v240, s83, v41
    v_dot2c_f32_bf16 v241, v41, v41
    v_dot2c_f32_bf16 v240, s83, v42
    v_dot2c_f32_bf16 v241, v42, v42
    v_dot2c_f32_bf16 v240, s83, v43
    v_dot2c_f32_bf16 v241, v43, v43
    buffer_load_dwordx4 v5, s[28:31], s62 offen offset:3072  lds
    v_dot2c_f32_bf16 v240, s83, v44
    v_dot2c_f32_bf16 v241, v44, v44
    v_dot2c_f32_bf16 v240, s83, v45
    v_dot2c_f32_bf16 v241, v45, v45
    v_dot2c_f32_bf16 v240, s83, v46
    v_dot2c_f32_bf16 v241, v46, v46
    v_dot2c_f32_bf16 v240, s83, v47
    v_dot2c_f32_bf16 v241, v47, v47
    s_waitcnt vmcnt(8)
    ds_read_b128 v[64:67], v6 offset:12288
    ds_read_b128 v[68:71], v7 offset:12288
    ds_read_b128 v[72:75], v8 offset:12288
    ds_read_b128 v[76:79], v9 offset:12288
    s_cmp_eq_u32 s90, 3
    s_cbranch_scc0 L_init2_3
    s_atomic_add s99, s[22:23], 0
L_init2_3:
    s_add_u32 m0, s72, 24576
    s_add_u32 s62, s62, 128
    s_cmp_eq_u32 s62, s63
    s_cselect_b32 s62, s61, s62
    buffer_load_dwordx4 v2, s[28:31], s62 offen offset:0  lds
    s_waitcnt lgkmcnt(4)
    v_dot2c_f32_bf16 v240, s83, v48
    v_dot2c_f32_bf16 v241, v48, v48
    v_dot2c_f32_bf16 v240, s83, v49
    v_dot2c_f32_bf16 v241, v49, v49
    v_dot2c_f32_bf16 v240, s83, v50
    v_dot2c_f32_bf16 v241, v50, v50
    v_dot2c_f32_bf16 v240, s83, v51
    v_dot2c_f32_bf16 v241, v51, v51
    buffer_load_dwordx4 v3, s[28:31], s62 offen offset:1024  lds
    v_dot2c_f32_bf16 v240, s83, v52
    v_dot2c_f32_bf16 v241, v52, v52
    v_dot2c_f32_bf16 v240, s83, v53
    v_dot2c_f32_bf16 v241, v53, v53
    v_dot2c_f32_bf16 v240, s83, v54
    v_dot2c_f32_bf16 v241, v54, v54
    v_dot2c_f32_bf16 v240, s83, v55
    v_dot2c_f32_bf16 v241, v55, v55
    buffer_load_dwordx4 v4, s[28:31], s62 offen offset:2048  lds
    v_dot2c_f32_bf16 v240, s83, v56
    v_dot2c_f32_bf16 v241, v56, v56
    v_dot2c_f32_bf16 v240, s83, v57
    v_dot2c_f32_bf16 v241, v57, v57
    v_dot2c_f32_bf16 v240, s83, v58
    v_dot2c_f32_bf16 v241, v58, v58
    v_dot2c_f32_bf16 v240, s83, v59
    v_dot2c_f32_bf16 v241, v59, v59
    buffer_load_dwordx4 v5, s[28:31], s62 offen offset:3072  lds
    v_dot2c_f32_bf16 v240, s83, v60
    v_dot2c_f32_bf16 v241, v60, v60
    v_dot2c_f32_bf16 v240, s83, v61
    v_dot2c_f32_bf16 v241, v61, v61
    v_dot2c_f32_bf16 v240, s83, v62
    v_dot2c_f32_bf16 v241, v62, v62
    v_dot2c_f32_bf16 v240, s83, v63
    v_dot2c_f32_bf16 v241, v63, v63
    s_waitcnt vmcnt(8)
    ds_read_b128 v[80:83], v6 offset:16384
    ds_read_b128 v[84:87], v7 offset:16384
    ds_read_b128 v[88:91], v8 offset:16384
    ds_read_b128 v[92:95], v9 offset:16384
    s_and_b32 s26, s71, 1024
    s_add_u32 m0, s71, 143360
    s_cmp_lt_u32 s3, 2
    s_cselect_b32 s27, s56, s85
    s_mul_i32 s27, s27, 1568
    s_add_u32 s26, s26, s27
    buffer_load_dwordx4 v1, s[36:39], s26 offen lds
    s_waitcnt lgkmcnt(4)
    v_dot2c_f32_bf16 v240, s83, v64
    v_dot2c_f32_bf16 v241, v64, v64
    v_dot2c_f32_bf16 v240, s83, v65
    v_dot2c_f32_bf16 v241, v65, v65
    v_dot2c_f32_bf16 v240, s83, v66
    v_dot2c_f32_bf16 v241, v66, v66
    v_dot2c_f32_bf16 v240, s83, v67
    v_dot2c_f32_bf16 v241, v67, v67
    s_add_u32 m0, s71, 113792
    s_mov_b32 s91, 0x1000
    buffer_load_dwordx4 v10, s[32:35], s64 offen offset:896 lds
    v_dot2c_f32_bf16 v240, s83, v68
    v_dot2c_f32_bf16 v241, v68, v68
    v_dot2c_f32_bf16 v240, s83, v69
    v_dot2c_f32_bf16 v241, v69, v69
    v_dot2c_f32_bf16 v240, s83, v70
    v_dot2c_f32_bf16 v241, v70, v70
    v_dot2c_f32_bf16 v240, s83, v71
    v_dot2c_f32_bf16 v241, v71, v71
    s_add_u32 m0, s71, 117888
    s_mov_b32 s91, 0x1000
    buffer_load_dwordx4 v10, s[32:35], s65 offen offset:896 lds
    v_dot2c_f32_bf16 v240, s83, v72
    v_dot2c_f32_bf16 v241, v72, v72
    v_dot2c_f32_bf16 v240, s83, v73
    v_dot2c_f32_bf16 v241, v73, v73
    v_dot2c_f32_bf16 v240, s83, v74
    v_dot2c_f32_bf16 v241, v74, v74
    v_dot2c_f32_bf16 v240, s83, v75
    v_dot2c_f32_bf16 v241, v75, v75
    s_add_u32 m0, s71, 121984
    s_mov_b32 s91, 0x1000
    buffer_load_dwordx4 v10, s[32:35], s66 offen offset:896 lds
    v_dot2c_f32_bf16 v240, s83, v76
    v_dot2c_f32_bf16 v241, v76, v76
    v_dot2c_f32_bf16 v240, s83, v77
    v_dot2c_f32_bf16 v241, v77, v77
    v_dot2c_f32_bf16 v240, s83, v78
    v_dot2c_f32_bf16 v241, v78, v78
    v_dot2c_f32_bf16 v240, s83, v79
    v_dot2c_f32_bf16 v241, v79, v79
    s_waitcnt vmcnt(8)
    ds_read_b128 v[96:99], v6 offset:20480
    ds_read_b128 v[100:103], v7 offset:20480
    ds_read_b128 v[104:107], v8 offset:20480
    ds_read_b128 v[108:111], v9 offset:20480
    s_add_u32 m0, s71, 126080
    s_mov_b32 s91, 0x1000
    buffer_load_dwordx4 v10, s[32:35], s67 offen offset:896 lds
    s_waitcnt lgkmcnt(4)
    v_dot2c_f32_bf16 v240, s83, v80
    v_dot2c_f32_bf16 v241, v80, v80
    v_dot2c_f32_bf16 v240, s83, v81
    v_dot2c_f32_bf16 v241, v81, v81
    v_dot2c_f32_bf16 v240, s83, v82
    v_dot2c_f32_bf16 v241, v82, v82
    v_dot2c_f32_bf16 v240, s83, v83
    v_dot2c_f32_bf16 v241, v83, v83
    v_dot2c_f32_bf16 v240, s83, v84
    v_dot2c_f32_bf16 v241, v84, v84
    v_dot2c_f32_bf16 v240, s83, v85
    v_dot2c_f32_bf16 v241, v85, v85
    v_dot2c_f32_bf16 v240, s83, v86
    v_dot2c_f32_bf16 v241, v86, v86
    v_dot2c_f32_bf16 v240, s83, v87
    v_dot2c_f32_bf16 v241, v87, v87
    s_add_u32 m0, s71, 130176
    s_mov_b32 s91, 0x1000
    buffer_load_dwordx4 v10, s[32:35], s68 offen offset:896 lds
    v_dot2c_f32_bf16 v240, s83, v88
    v_dot2c_f32_bf16 v241, v88, v88
    v_dot2c_f32_bf16 v240, s83, v89
    v_dot2c_f32_bf16 v241, v89, v89
    v_dot2c_f32_bf16 v240, s83, v90
    v_dot2c_f32_bf16 v241, v90, v90
    v_dot2c_f32_bf16 v240, s83, v91
    v_dot2c_f32_bf16 v241, v91, v91
    v_dot2c_f32_bf16 v240, s83, v92
    v_dot2c_f32_bf16 v241, v92, v92
    v_dot2c_f32_bf16 v240, s83, v93
    v_dot2c_f32_bf16 v241, v93, v93
    v_dot2c_f32_bf16 v240, s83, v94
    v_dot2c_f32_bf16 v241, v94, v94
    v_dot2c_f32_bf16 v240, s83, v95
    v_dot2c_f32_bf16 v241, v95, v95
    s_waitcnt vmcnt(6)
    ds_read_b128 v[112:115], v6 offset:24576
    ds_read_b128 v[116:119], v7 offset:24576
    ds_read_b128 v[120:123], v8 offset:24576
    ds_read_b128 v[124:127], v9 offset:24576
    s_waitcnt lgkmcnt(4)
    v_dot2c_f32_bf16 v240, s83, v96
    v_dot2c_f32_bf16 v241, v96, v96
    v_dot2c_f32_bf16 v240, s83, v97
    v_dot2c_f32_bf16 v241, v97, v97
    v_dot2c_f32_bf16 v240, s83, v98
    v_dot2c_f32_bf16 v241, v98, v98
    v_dot2c_f32_bf16 v240, s83, v99
    v_dot2c_f32_bf16 v241, v99, v99
    v_dot2c_f32_bf16 v240, s83, v100
    v_dot2c_f32_bf16 v241, v100, v100
    v_dot2c_f32_bf16 v240, s83, v101
    v_dot2c_f32_bf16 v241, v101, v101
    v_dot2c_f32_bf16 v240, s83, v102
    v_dot2c_f32_bf16 v241, v102, v102
    v_dot2c_f32_bf16 v240, s83, v103
    v_dot2c_f32_bf16 v241, v103, v103
    v_dot2c_f32_bf16 v240, s83, v104
    v_dot2c_f32_bf16 v241, v104, v104
    v_dot2c_f32_bf16 v240, s83, v105
    v_dot2c_f32_bf16 v241, v105, v105
    v_dot2c_f32_bf16 v240, s83, v106
    v_dot2c_f32_bf16 v241, v106, v106
    v_dot2c_f32_bf16 v240, s83, v107
    v_dot2c_f32_bf16 v241, v107, v107
    v_dot2c_f32_bf16 v240, s83, v108
    v_dot2c_f32_bf16 v241, v108, v108
    v_dot2c_f32_bf16 v240, s83, v109
    v_dot2c_f32_bf16 v241, v109, v109
    v_dot2c_f32_bf16 v240, s83, v110
    v_dot2c_f32_bf16 v241, v110, v110
    v_dot2c_f32_bf16 v240, s83, v111
    v_dot2c_f32_bf16 v241, v111, v111
    v_lshrrev_b32 v160, 4, v0
    v_bfe_u32 v161, v0, 2, 2
    v_xor_b32 v160, v160, v161
    v_bfe_u32 v161, v0, 1, 1
    v_lshl_add_u32 v160, v160, 1, v161
    v_and_b32 v161, 1, v0
    v_lshlrev_b32 v161, 4, v161
    v_lshlrev_b32 v161, v161, s81
    v_cmp_eq_u32 vcc, 0, v160
    v_accvgpr_write_b32 a250, 0
    v_accvgpr_write_b32 a254, 0
    v_cndmask_b32 v162, 0, v161, vcc
    v_accvgpr_write_b32 a252, v162
    v_cmp_eq_u32 vcc, 1, v160
    v_accvgpr_write_b32 a251, 0
    v_accvgpr_write_b32 a255, 0
    v_cndmask_b32 v162, 0, v161, vcc
    v_accvgpr_write_b32 a253, v162
    s_waitcnt lgkmcnt(0)
    s_barrier
    v_dot2c_f32_bf16 v240, s83, v112
    v_dot2c_f32_bf16 v241, v112, v112
    v_dot2c_f32_bf16 v240, s83, v113
    v_dot2c_f32_bf16 v241, v113, v113
    v_dot2c_f32_bf16 v240, s83, v114
    v_dot2c_f32_bf16 v241, v114, v114
    v_dot2c_f32_bf16 v240, s83, v115
    v_dot2c_f32_bf16 v241, v115, v115
    v_dot2c_f32_bf16 v240, s83, v116
    v_dot2c_f32_bf16 v241, v116, v116
    v_dot2c_f32_bf16 v240, s83, v117
    v_dot2c_f32_bf16 v241, v117, v117
    v_dot2c_f32_bf16 v240, s83, v118
    v_dot2c_f32_bf16 v241, v118, v118
    v_dot2c_f32_bf16 v240, s83, v119
    v_dot2c_f32_bf16 v241, v119, v119
    v_dot2c_f32_bf16 v240, s83, v120
    v_dot2c_f32_bf16 v241, v120, v120
    v_dot2c_f32_bf16 v240, s83, v121
    v_dot2c_f32_bf16 v241, v121, v121
    v_dot2c_f32_bf16 v240, s83, v122
    v_dot2c_f32_bf16 v241, v122, v122
    v_dot2c_f32_bf16 v240, s83, v123
    v_dot2c_f32_bf16 v241, v123, v123
    v_dot2c_f32_bf16 v240, s83, v124
    v_dot2c_f32_bf16 v241, v124, v124
    v_dot2c_f32_bf16 v240, s83, v125
    v_dot2c_f32_bf16 v241, v125, v125
    v_dot2c_f32_bf16 v240, s83, v126
    v_dot2c_f32_bf16 v241, v126, v126
    v_dot2c_f32_bf16 v240, s83, v127
    v_dot2c_f32_bf16 v241, v127, v127
    s_nop 2
    v_permlane32_swap_b32 v240, v241
    v_add_f32 v240, v240, v241
    v_mul_f32 v241, 0xbb124925, v240
    v_mul_f32 v240, 0xbb124925, v240
    s_nop 1
    v_permlane32_swap_b32 v240, v241
    v_pk_mul_f32 v[224:225], v[240:241], 1.0 op_sel_hi:[0,0]
    v_pk_mul_f32 v[226:227], v[240:241], 1.0 op_sel_hi:[0,0]
    s_nop 1
    v_mfma_f32_16x16x32_bf16 v[160:163], a[252:255], v[16:19], v[224:227]
    v_fma_f32 v241, -v240, v240, -v241
    v_max_f32 v241, 0, v241
    v_add_f32 v241, 0x3727c5ac, v241
    v_sqrt_f32 v241, v241
    s_nop 0
    v_cvt_pk_bf16_f32 v5, v241, v241
    v_and_b32 v4, 0xffff0000, v5
    v_rcp_f32 v4, v4
    s_sub_u32 s61, s85, s56
    s_mul_i32 s61, s61, 56
    v_mfma_f32_16x16x32_bf16 v[164:167], a[250:253], v[16:19], v[224:227]
    v_mfma_f32_16x16x32_bf16 v[192:195], a[252:255], v[20:23], v[224:227]
    s_cmp_lt_u32 s98, 5
    s_cbranch_scc0 L_init_4
    s_and_b32 s13, s98, 1
    s_lshl_b32 s13, s13, 5
    s_add_u32 s13, s13, s98
    s_lshl_b32 s13, s13, 8
    s_xor_b32 s91, s13, 8192
    s_waitcnt lgkmcnt(0)
    s_mov_b32 s14, 0
    s_mov_b32 s15, 0
    s_atomic_umax s14, s[24:25], s13 offset:49152 glc
    s_atomic_umax s15, s[24:25], s91 offset:49152 glc
    s_waitcnt lgkmcnt(1)
    s_lshr_b32 s63, s98, 2
    s_xor_b32 s63, s63, s98
    s_nop 2
    s_xor_b32 s63, s63, s15
    s_waitcnt lgkmcnt(0)
    s_and_b32 s63, s63, 1
    s_lshl_b32 s63, s63, 16
    s_add_u32 s63, s63, 1
    s_atomic_add s63, s[22:23], 0
L_init_4:
    v_mfma_f32_16x16x32_bf16 v[196:199], a[250:253], v[20:23], v[224:227]
    v_mfma_f32_16x16x32_bf16 v[208:211], a[252:255], v[24:27], v[224:227]
    s_add_u32 m0, s71, 134272
    s_mov_b32 s91, 0x1000
    buffer_load_dwordx4 v10, s[32:35], s69 offen offset:896 lds
    v_mfma_f32_16x16x32_bf16 v[212:215], a[250:253], v[24:27], v[224:227]
    v_mfma_f32_16x16x32_bf16 v[176:179], a[252:255], v[28:31], v[224:227]
    v_cvt_pk_bf16_f32 v16, v160, v161
    v_cvt_pk_bf16_f32 v17, v162, v163
    v_mfma_f32_16x16x32_bf16 v[180:183], a[250:253], v[28:31], v[224:227]
    v_cvt_pk_bf16_f32 v18, v164, v165
    v_cvt_pk_bf16_f32 v19, v166, v167
    v_mfma_f32_16x16x32_bf16 v[160:163], a[252:255], v[32:35], v[224:227]
    v_cvt_pk_bf16_f32 v20, v192, v193
    v_cvt_pk_bf16_f32 v21, v194, v195
    v_mfma_f32_16x16x32_bf16 v[164:167], a[250:253], v[32:35], v[224:227]
    v_cvt_pk_bf16_f32 v22, v196, v197
    v_cvt_pk_bf16_f32 v23, v198, v199
    v_mfma_f32_16x16x32_bf16 v[192:195], a[252:255], v[36:39], v[224:227]
    v_cvt_pk_bf16_f32 v24, v208, v209
    v_cvt_pk_bf16_f32 v25, v210, v211
    v_mfma_f32_16x16x32_bf16 v[196:199], a[250:253], v[36:39], v[224:227]
    v_cvt_pk_bf16_f32 v26, v212, v213
    v_cvt_pk_bf16_f32 v27, v214, v215
    v_mfma_f32_16x16x32_bf16 v[208:211], a[252:255], v[40:43], v[224:227]
    v_cvt_pk_bf16_f32 v28, v176, v177
    v_cvt_pk_bf16_f32 v29, v178, v179
    v_mfma_f32_16x16x32_bf16 v[212:215], a[250:253], v[40:43], v[224:227]
    v_cvt_pk_bf16_f32 v30, v180, v181
    v_cvt_pk_bf16_f32 v31, v182, v183
    v_mfma_f32_16x16x32_bf16 v[176:179], a[252:255], v[44:47], v[224:227]
    v_cvt_pk_bf16_f32 v32, v160, v161
    v_cvt_pk_bf16_f32 v33, v162, v163
    v_mfma_f32_16x16x32_bf16 v[180:183], a[250:253], v[44:47], v[224:227]
    v_cvt_pk_bf16_f32 v34, v164, v165
    v_cvt_pk_bf16_f32 v35, v166, v167
    v_mfma_f32_16x16x32_bf16 v[160:163], a[252:255], v[48:51], v[224:227]
    s_add_u32 m0, s71, 138368
    s_mov_b32 s91, 0x1000
    buffer_load_dwordx4 v10, s[32:35], s70 offen offset:896 lds
    v_cvt_pk_bf16_f32 v36, v192, v193
    v_cvt_pk_bf16_f32 v37, v194, v195
    v_mfma_f32_16x16x32_bf16 v[164:167], a[250:253], v[48:51], v[224:227]
    v_cvt_pk_bf16_f32 v38, v196, v197
    v_cvt_pk_bf16_f32 v39, v198, v199
    v_mfma_f32_16x16x32_bf16 v[192:195], a[252:255], v[52:55], v[224:227]
    v_cvt_pk_bf16_f32 v40, v208, v209
    v_cvt_pk_bf16_f32 v41, v210, v211
    v_mfma_f32_16x16x32_bf16 v[196:199], a[250:253], v[52:55], v[224:227]
    v_cvt_pk_bf16_f32 v42, v212, v213
    v_cvt_pk_bf16_f32 v43, v214, v215
    v_mfma_f32_16x16x32_bf16 v[208:211], a[252:255], v[56:59], v[224:227]
    v_cvt_pk_bf16_f32 v44, v176, v177
    v_cvt_pk_bf16_f32 v45, v178, v179
    v_mfma_f32_16x16x32_bf16 v[212:215], a[250:253], v[56:59], v[224:227]
    v_cvt_pk_bf16_f32 v46, v180, v181
    v_cvt_pk_bf16_f32 v47, v182, v183
    v_mfma_f32_16x16x32_bf16 v[176:179], a[252:255], v[60:63], v[224:227]
    v_cvt_pk_bf16_f32 v48, v160, v161
    v_cvt_pk_bf16_f32 v49, v162, v163
    v_mfma_f32_16x16x32_bf16 v[180:183], a[250:253], v[60:63], v[224:227]
    v_cvt_pk_bf16_f32 v50, v164, v165
    v_cvt_pk_bf16_f32 v51, v166, v167
    v_mfma_f32_16x16x32_bf16 v[160:163], a[252:255], v[64:67], v[224:227]
    v_cvt_pk_bf16_f32 v52, v192, v193
    v_cvt_pk_bf16_f32 v53, v194, v195
    v_mfma_f32_16x16x32_bf16 v[164:167], a[250:253], v[64:67], v[224:227]
    v_cvt_pk_bf16_f32 v54, v196, v197
    v_cvt_pk_bf16_f32 v55, v198, v199
    v_mfma_f32_16x16x32_bf16 v[192:195], a[252:255], v[68:71], v[224:227]
    v_cvt_pk_bf16_f32 v56, v208, v209
    v_cvt_pk_bf16_f32 v57, v210, v211
    v_mfma_f32_16x16x32_bf16 v[196:199], a[250:253], v[68:71], v[224:227]
    v_cvt_pk_bf16_f32 v58, v212, v213
    v_cvt_pk_bf16_f32 v59, v214, v215
    v_mfma_f32_16x16x32_bf16 v[208:211], a[252:255], v[72:75], v[224:227]
    s_add_u32 m0, s71, 0
    s_nop 0
    s_add_u32 s91, s64, 1792
    buffer_load_dwordx4 v10, s[32:35], s91 offen lds
    v_cvt_pk_bf16_f32 v60, v176, v177
    v_cvt_pk_bf16_f32 v61, v178, v179
    v_mfma_f32_16x16x32_bf16 v[212:215], a[250:253], v[72:75], v[224:227]
    v_cvt_pk_bf16_f32 v62, v180, v181
    v_cvt_pk_bf16_f32 v63, v182, v183
    v_mfma_f32_16x16x32_bf16 v[176:179], a[252:255], v[76:79], v[224:227]
    v_cvt_pk_bf16_f32 v64, v160, v161
    v_cvt_pk_bf16_f32 v65, v162, v163
    v_mfma_f32_16x16x32_bf16 v[180:183], a[250:253], v[76:79], v[224:227]
    v_cvt_pk_bf16_f32 v66, v164, v165
    v_cvt_pk_bf16_f32 v67, v166, v167
    v_mfma_f32_16x16x32_bf16 v[160:163], a[252:255], v[80:83], v[224:227]
    v_cvt_pk_bf16_f32 v68, v192, v193
    v_cvt_pk_bf16_f32 v69, v194, v195
    v_mfma_f32_16x16x32_bf16 v[164:167], a[250:253], v[80:83], v[224:227]
    v_cvt_pk_bf16_f32 v70, v196, v197
    v_cvt_pk_bf16_f32 v71, v198, v199
    v_mfma_f32_16x16x32_bf16 v[192:195], a[252:255], v[84:87], v[224:227]
    v_cvt_pk_bf16_f32 v72, v208, v209
    v_cvt_pk_bf16_f32 v73, v210, v211
    v_mfma_f32_16x16x32_bf16 v[196:199], a[250:253], v[84:87], v[224:227]
    v_cvt_pk_bf16_f32 v74, v212, v213
    v_cvt_pk_bf16_f32 v75, v214, v215
    v_mfma_f32_16x16x32_bf16 v[208:211], a[252:255], v[88:91], v[224:227]
    v_cvt_pk_bf16_f32 v76, v176, v177
    v_cvt_pk_bf16_f32 v77, v178, v179
    v_mfma_f32_16x16x32_bf16 v[212:215], a[250:253], v[88:91], v[224:227]
    v_cvt_pk_bf16_f32 v78, v180, v181
    v_cvt_pk_bf16_f32 v79, v182, v183
    v_mfma_f32_16x16x32_bf16 v[176:179], a[252:255], v[92:95], v[224:227]
    v_cvt_pk_bf16_f32 v80, v160, v161
    v_cvt_pk_bf16_f32 v81, v162, v163
    v_mfma_f32_16x16x32_bf16 v[180:183], a[250:253], v[92:95], v[224:227]
    v_cvt_pk_bf16_f32 v82, v164, v165
    v_cvt_pk_bf16_f32 v83, v166, v167
    v_mfma_f32_16x16x32_bf16 v[160:163], a[252:255], v[96:99], v[224:227]
    s_add_u32 m0, s71, 2304
    s_mov_b32 s91, 0x1000
    buffer_load_dwordx4 v10, s[32:35], s65 offen offset:1792 lds
    v_cvt_pk_bf16_f32 v84, v192, v193
    v_cvt_pk_bf16_f32 v85, v194, v195
    v_mfma_f32_16x16x32_bf16 v[164:167], a[250:253], v[96:99], v[224:227]
    v_cvt_pk_bf16_f32 v86, v196, v197
    v_cvt_pk_bf16_f32 v87, v198, v199
    v_mfma_f32_16x16x32_bf16 v[192:195], a[252:255], v[100:103], v[224:227]
    global_load_dword a248, v159, s[88:89]
    s_waitcnt vmcnt(6)
    s_barrier
    v_cvt_pk_bf16_f32 v88, v208, v209
    v_cvt_pk_bf16_f32 v89, v210, v211
    v_mfma_f32_16x16x32_bf16 v[196:199], a[250:253], v[100:103], v[224:227]
    v_cvt_pk_bf16_f32 v90, v212, v213
    v_cvt_pk_bf16_f32 v91, v214, v215
    v_mfma_f32_16x16x32_bf16 v[208:211], a[252:255], v[104:107], v[224:227]
    ds_read_b64_tr_b16 v[128:129], v12 offset:0
    ds_read_b64_tr_b16 v[130:131], v12 offset:256
    v_cvt_pk_bf16_f32 v92, v176, v177
    v_cvt_pk_bf16_f32 v93, v178, v179
    v_mfma_f32_16x16x32_bf16 v[212:215], a[250:253], v[104:107], v[224:227]
    v_cvt_pk_bf16_f32 v94, v180, v181
    v_cvt_pk_bf16_f32 v95, v182, v183
    v_mfma_f32_16x16x32_bf16 v[176:179], a[252:255], v[108:111], v[224:227]
    ds_read_b64_tr_b16 v[132:133], v12 offset:1024
    ds_read_b64_tr_b16 v[134:135], v12 offset:1280
    v_cvt_pk_bf16_f32 v96, v160, v161
    v_cvt_pk_bf16_f32 v97, v162, v163
    v_mfma_f32_16x16x32_bf16 v[180:183], a[250:253], v[108:111], v[224:227]
    v_cvt_pk_bf16_f32 v98, v164, v165
    v_cvt_pk_bf16_f32 v99, v166, v167
    v_mfma_f32_16x16x32_bf16 v[160:163], a[252:255], v[112:115], v[224:227]
    ds_read_b64_tr_b16 v[136:137], v12 offset:2048
    ds_read_b64_tr_b16 v[138:139], v12 offset:2304
    v_cvt_pk_bf16_f32 v100, v192, v193
    v_cvt_pk_bf16_f32 v101, v194, v195
    v_mfma_f32_16x16x32_bf16 v[164:167], a[250:253], v[112:115], v[224:227]
    v_cvt_pk_bf16_f32 v102, v196, v197
    v_cvt_pk_bf16_f32 v103, v198, v199
    v_mfma_f32_16x16x32_bf16 v[192:195], a[252:255], v[116:119], v[224:227]
    ds_read_b64_tr_b16 v[140:141], v12 offset:3072
    ds_read_b64_tr_b16 v[142:143], v12 offset:3328
    v_cvt_pk_bf16_f32 v104, v208, v209
    v_cvt_pk_bf16_f32 v105, v210, v211
    v_mfma_f32_16x16x32_bf16 v[196:199], a[250:253], v[116:119], v[224:227]
    v_cvt_pk_bf16_f32 v106, v212, v213
    v_cvt_pk_bf16_f32 v107, v214, v215
    v_mfma_f32_16x16x32_bf16 v[208:211], a[252:255], v[120:123], v[224:227]
    s_add_u32 m0, s71, 6400
    s_mov_b32 s91, 0x1000
    buffer_load_dwordx4 v10, s[32:35], s66 offen offset:1792 lds
    ds_read_b64_tr_b16 v[144:145], v12 offset:4096
    ds_read_b64_tr_b16 v[146:147], v12 offset:4352
    v_cvt_pk_bf16_f32 v108, v176, v177
    v_cvt_pk_bf16_f32 v109, v178, v179
    v_mfma_f32_16x16x32_bf16 v[212:215], a[250:253], v[120:123], v[224:227]
    v_cvt_pk_bf16_f32 v110, v180, v181
    v_cvt_pk_bf16_f32 v111, v182, v183
    v_mfma_f32_16x16x32_bf16 v[176:179], a[252:255], v[124:127], v[224:227]
    ds_read_b64_tr_b16 v[148:149], v12 offset:5120
    ds_read_b64_tr_b16 v[150:151], v12 offset:5376
    v_cvt_pk_bf16_f32 v112, v160, v161
    v_cvt_pk_bf16_f32 v113, v162, v163
    v_mfma_f32_16x16x32_bf16 v[180:183], a[250:253], v[124:127], v[224:227]
    v_cvt_pk_bf16_f32 v114, v164, v165
    v_cvt_pk_bf16_f32 v115, v166, v167
    s_waitcnt lgkmcnt(10)
    v_mfma_f32_32x32x16_bf16 v[160:175], v[128:131], v[16:19], 0
    s_add_u32 m0, s71, 10496
    s_mov_b32 s91, 0x1000
    buffer_load_dwordx4 v10, s[32:35], s67 offen offset:1792 lds
    ds_read_b64_tr_b16 v[152:153], v12 offset:6144
    ds_read_b64_tr_b16 v[154:155], v12 offset:6400
    s_waitcnt lgkmcnt(10)
    v_mfma_f32_32x32x16_bf16 v[160:175], v[132:135], v[20:23], v[160:175]
    ds_read_b64_tr_b16 v[246:247], v244 offset:0
    ds_read_b64_tr_b16 v[248:249], v244 offset:448
    ds_read_b64_tr_b16 v[250:251], v244 offset:896
    ds_read_b64_tr_b16 v[252:253], v244 offset:1344
    ds_read_b64_tr_b16 v[156:157], v12 offset:7168
    ds_read_b64_tr_b16 v[158:159], v12 offset:7424
    s_waitcnt lgkmcnt(12)
    s_nop 0
    v_mfma_f32_32x32x16_bf16 v[160:175], v[136:139], v[24:27], v[160:175]
    s_add_u32 m0, s71, 14592
    s_mov_b32 s91, 0x1000
    buffer_load_dwordx4 v10, s[32:35], s68 offen offset:1792 lds
    ds_read_b64_tr_b16 v[128:129], v12 offset:8192
    ds_read_b64_tr_b16 v[130:131], v12 offset:8448
    v_cvt_pk_bf16_f32 v116, v192, v193
    v_mfma_f32_32x32x16_bf16 v[160:175], v[140:143], v[28:31], v[160:175]
    ds_read_b64_tr_b16 v[132:133], v12 offset:9216
    ds_read_b64_tr_b16 v[134:135], v12 offset:9472
    v_cvt_pk_bf16_f32 v117, v194, v195
    v_cvt_pk_bf16_f32 v118, v196, v197
    v_cvt_pk_bf16_f32 v119, v198, v199
    s_waitcnt lgkmcnt(12)
    s_nop 0
    v_mfma_f32_32x32x16_bf16 v[160:175], v[144:147], v[32:35], v[160:175]
    s_add_u32 m0, s71, 18688
    s_mov_b32 s91, 0x1000
    buffer_load_dwordx4 v10, s[32:35], s69 offen offset:1792 lds
    ds_read_b64_tr_b16 v[136:137], v12 offset:10240
    ds_read_b64_tr_b16 v[138:139], v12 offset:10496
    v_cvt_pk_bf16_f32 v120, v208, v209
    v_mfma_f32_32x32x16_bf16 v[160:175], v[148:151], v[36:39], v[160:175]
    ds_read_b64_tr_b16 v[140:141], v12 offset:11264
    ds_read_b64_tr_b16 v[142:143], v12 offset:11520
    v_cvt_pk_bf16_f32 v121, v210, v211
    v_cvt_pk_bf16_f32 v122, v212, v213
    v_cvt_pk_bf16_f32 v123, v214, v215
    s_waitcnt lgkmcnt(8)
    s_nop 0
    v_mfma_f32_32x32x16_bf16 v[160:175], v[152:155], v[40:43], v[160:175]
    s_add_u32 m0, s71, 22784
    s_mov_b32 s91, 0x1000
    buffer_load_dwordx4 v10, s[32:35], s70 offen offset:1792 lds
    ds_read_b64_tr_b16 v[144:145], v12 offset:12288
    ds_read_b64_tr_b16 v[146:147], v12 offset:12544
    v_cvt_pk_bf16_f32 v124, v176, v177
    v_mfma_f32_32x32x16_bf16 v[160:175], v[156:159], v[44:47], v[160:175]
    ds_read_b64_tr_b16 v[148:149], v12 offset:13312
    ds_read_b64_tr_b16 v[150:151], v12 offset:13568
    v_cvt_pk_bf16_f32 v125, v178, v179
    v_cvt_pk_bf16_f32 v126, v180, v181
    v_cvt_pk_bf16_f32 v127, v182, v183
    s_waitcnt lgkmcnt(8)
    v_mfma_f32_32x32x16_bf16 v[160:175], v[128:131], v[48:51], v[160:175]
    ds_read_b64_tr_b16 v[152:153], v12 offset:14336
    ds_read_b64_tr_b16 v[154:155], v12 offset:14592
    v_lshrrev_b32 v2, 4, v0
L_pad1:
    s_cbranch_execz L_body
    v_lshlrev_b32 v3, 2, v2
    v_xor_b32 v3, v3, v0
    v_and_b32 v3, 15, v3
    v_mfma_f32_32x32x16_bf16 v[160:175], v[132:135], v[52:55], v[160:175]
    s_add_u32 m0, s71, 28672
    s_add_u32 s91, s64, s61
    buffer_load_dwordx4 v10, s[32:35], s91 offen lds
    ds_read_b64_tr_b16 v[156:157], v12 offset:15360
    ds_read_b64_tr_b16 v[158:159], v12 offset:15616
    s_waitcnt lgkmcnt(8)
    v_mfma_f32_32x32x16_bf16 v[160:175], v[136:139], v[56:59], v[160:175]
    v_lshlrev_b32 v3, 4, v3
    v_mul_u32_u24 v2, 3584, v2
    s_waitcnt vmcnt(11)
    s_barrier
    ds_read_b64_tr_b16 v[128:129], v12 offset:16384
    ds_read_b64_tr_b16 v[130:131], v12 offset:16640
    v_mfma_f32_32x32x16_bf16 v[160:175], v[140:143], v[60:63], v[160:175]
    ds_read_b64_tr_b16 v[132:133], v12 offset:17408
    ds_read_b64_tr_b16 v[134:135], v12 offset:17664
    v_add_u32 v240, v2, v3
    s_sub_u32 s12, s78, 1
    v_and_b32 v240, s12, v240
    s_waitcnt lgkmcnt(8)
    s_nop 0
    v_mfma_f32_32x32x16_bf16 v[160:175], v[144:147], v[64:67], v[160:175]
    ds_read_b64_tr_b16 v[136:137], v12 offset:18432
    ds_read_b64_tr_b16 v[138:139], v12 offset:18688
    v_add_u32 v241, 13312, v240
    v_add_u32 v242, 26624, v240
    v_add_u32 v245, 39936, v240
    s_mul_i32 s26, s3, 6656
    v_mfma_f32_32x32x16_bf16 v[160:175], v[148:151], v[68:71], v[160:175]
    ds_read_b64_tr_b16 v[140:141], v12 offset:19456
    ds_read_b64_tr_b16 v[142:143], v12 offset:19712
    s_add_u32 s26, s26, 114688
    v_lshrrev_b32 v2, 5, v0
    v_lshl_add_u32 v3, v2, 7, v1
    s_waitcnt lgkmcnt(8)
    v_mfma_f32_32x32x16_bf16 v[160:175], v[152:155], v[72:75], v[160:175]
    v_add_u32 v6, s26, v3
    v_add_u32 v7, s26, v1
    s_waitcnt vmcnt(10)
    s_barrier
    ds_read_b64_tr_b16 v[144:145], v12 offset:20480
    ds_read_b64_tr_b16 v[146:147], v12 offset:20736
    v_mfma_f32_32x32x16_bf16 v[160:175], v[156:159], v[76:79], v[160:175]
    ds_read_b64_tr_b16 v[148:149], v12 offset:21504
    ds_read_b64_tr_b16 v[150:151], v12 offset:21760
    s_mul_i32 s26, s3, 1152
    s_add_u32 s26, s26, 114688
    v_bfe_u32 v3, v0, 2, 3
    s_waitcnt lgkmcnt(8)
    v_mfma_f32_32x32x16_bf16 v[160:175], v[128:131], v[80:83], v[160:175]
    ds_read_b64_tr_b16 v[152:153], v12 offset:22528
    ds_read_b64_tr_b16 v[154:155], v12 offset:22784
    v_lshl_add_u32 v3, v2, 4, v3
    v_lshlrev_b32 v3, 4, v3
    v_and_b32 v8, 1, v0
    v_mul_u32_u24 v8, 640, v8
    v_mfma_f32_32x32x16_bf16 v[160:175], v[132:135], v[84:87], v[160:175]
    s_add_u32 m0, s71, 32768
    s_add_u32 s91, s65, s61
    buffer_load_dwordx4 v10, s[32:35], s91 offen lds
    ds_read_b64_tr_b16 v[156:157], v12 offset:23552
    ds_read_b64_tr_b16 v[158:159], v12 offset:23808
    s_waitcnt lgkmcnt(8)
    v_mfma_f32_32x32x16_bf16 v[160:175], v[136:139], v[88:91], v[160:175]
    v_add_u32 v3, v3, v8
    v_bfe_u32 v8, v0, 1, 1
    s_waitcnt vmcnt(10)
    s_barrier
    ds_read_b64_tr_b16 v[128:129], v12 offset:24576
    ds_read_b64_tr_b16 v[130:131], v12 offset:24832
    v_mfma_f32_32x32x16_bf16 v[160:175], v[140:143], v[92:95], v[160:175]
    ds_read_b64_tr_b16 v[132:133], v12 offset:25600
    ds_read_b64_tr_b16 v[134:135], v12 offset:25856
    v_lshl_add_u32 v3, v8, 3, v3
    v_add_u32 v8, s26, v3
    v_lshrrev_b32 v3, 4, v0
    s_waitcnt lgkmcnt(8)
    v_mfma_f32_32x32x16_bf16 v[160:175], v[144:147], v[96:99], v[160:175]
    ds_read_b64_tr_b16 v[136:137], v12 offset:26624
    ds_read_b64_tr_b16 v[138:139], v12 offset:26880
    v_lshlrev_b32 v3, 9, v3
    v_and_b32 v9, 15, v0
    v_lshl_add_u32 v3, v9, 4, v3
    v_add_u32 v9, 119296, v3
    v_mfma_f32_32x32x16_bf16 v[160:175], v[148:151], v[100:103], v[160:175]
    ds_read_b64_tr_b16 v[140:141], v12 offset:27648
    ds_read_b64_tr_b16 v[142:143], v12 offset:27904
    s_lshl_b32 s90, s56, 2
    s_bfe_u32 s26, s57, 0x20001
    s_add_u32 s90, s90, s26
    s_waitcnt lgkmcnt(8)
    v_mfma_f32_32x32x16_bf16 v[160:175], v[152:155], v[104:107], v[160:175]
    s_lshr_b32 s26, s57, 3
    s_lshl1_add_u32 s90, s90, s26
    s_and_b32 s26, s57, 1
    s_lshl1_add_u32 s90, s90, s26
    s_lshl2_add_u32 s90, s90, s3
    s_lshl_b32 s90, s90, 10
    v_mfma_f32_32x32x16_bf16 v[160:175], v[156:159], v[108:111], v[160:175]
    s_add_u32 s90, s90, 65536
    s_mul_i32 s26, s3, 6656
    s_add_u32 s26, s26, 119744
    s_waitcnt vmcnt(6)
    s_barrier
    s_waitcnt lgkmcnt(4)
    v_mfma_f32_32x32x16_bf16 v[160:175], v[128:131], v[112:115], v[160:175]
    ds_read_b64_tr_b16 v[144:145], v11 offset:0
    ds_read_b64_tr_b16 v[146:147], v11 offset:256
    v_bfe_u32 v3, v0, 4, 1
    v_lshlrev_b32 v3, 10, v3
    v_bfe_u32 v224, v0, 2, 1
    v_lshl_add_u32 v3, v224, 9, v3
    v_mfma_f32_32x32x16_bf16 v[160:175], v[132:135], v[116:119], v[160:175]
    ds_read_b64_tr_b16 v[148:149], v11 offset:1024
    ds_read_b64_tr_b16 v[150:151], v11 offset:1280
    v_and_b32 v224, 8, v0
    v_add_u32 v3, v3, v224
    v_and_b32 v224, 3, v0
    s_waitcnt lgkmcnt(4)
    v_mfma_f32_32x32x16_bf16 v[160:175], v[136:139], v[120:123], v[160:175]
    s_add_u32 m0, s71, 36864
    s_add_u32 s91, s66, s61
    buffer_load_dwordx4 v10, s[32:35], s91 offen lds
    ds_read_b64_tr_b16 v[152:153], v11 offset:2048
    ds_read_b64_tr_b16 v[154:155], v11 offset:2304
    v_lshl_add_u32 v3, v224, 1, v3
    v_mfma_f32_32x32x16_bf16 v[160:175], v[140:143], v[124:127], v[160:175]
    ds_read_b64_tr_b16 v[156:157], v11 offset:3072
    ds_read_b64_tr_b16 v[158:159], v11 offset:3328
    v_add_u32 v3, s26, v3
    v_and_b32 v252, v252, v13
    v_and_b32 v253, v253, v13
    s_waitcnt lgkmcnt(6)
    v_mfma_f32_32x32x16_bf16 v[176:191], v[16:19], v[144:147], 0
    global_load_dword v15, v243, s[22:23] sc1
    ds_read_b64_tr_b16 v[128:129], v11 offset:4096
    ds_read_b64_tr_b16 v[130:131], v11 offset:4352
    s_waitcnt lgkmcnt(6)
    v_mfma_f32_32x32x16_bf16 v[176:191], v[20:23], v[148:151], v[176:191]
    ds_read_b64_tr_b16 v[132:133], v11 offset:5120
    ds_read_b64_tr_b16 v[134:135], v11 offset:5376
    v_mul_f32 v160, v160, v4
    v_mul_f32 v161, v161, v4
    v_mul_f32 v162, v162, v4
    v_mul_f32 v163, v163, v4
    v_mul_f32 v164, v164, v4
    v_mul_f32 v165, v165, v4
    v_mul_f32 v166, v166, v4
    v_mul_f32 v167, v167, v4
    v_cvt_pk_bf16_f32 v208, v160, v161
    v_cvt_pk_bf16_f32 v209, v162, v163
    s_waitcnt lgkmcnt(4)
    v_mfma_f32_32x32x16_bf16 v[176:191], v[24:27], v[152:155], v[176:191]
    s_add_u32 m0, s71, 40960
    s_add_u32 s91, s67, s61
    buffer_load_dwordx4 v10, s[32:35], s91 offen lds
    ds_read_b64_tr_b16 v[136:137], v11 offset:6144
    ds_read_b64_tr_b16 v[138:139], v11 offset:6400
    v_cvt_pk_bf16_f32 v210, v164, v165
    v_cvt_pk_bf16_f32 v211, v166, v167
    v_mul_f32 v168, v168, v4
    v_mul_f32 v169, v169, v4
    v_mul_f32 v170, v170, v4
    v_mul_f32 v171, v171, v4
    v_mul_f32 v172, v172, v4
    v_mul_f32 v173, v173, v4
    v_mfma_f32_32x32x16_bf16 v[176:191], v[28:31], v[156:159], v[176:191]
    ds_read_b64_tr_b16 v[140:141], v11 offset:7168
    ds_read_b64_tr_b16 v[142:143], v11 offset:7424
    v_mul_f32 v174, v174, v4
    v_mul_f32 v175, v175, v4
    v_cvt_pk_bf16_f32 v212, v168, v169
    v_cvt_pk_bf16_f32 v213, v170, v171
    v_cvt_pk_bf16_f32 v214, v172, v173
    v_cvt_pk_bf16_f32 v215, v174, v175
    v_mfma_f32_32x32x16_bf16 v[192:207], v[246:249], v[208:211], 0
    s_nop 0
    v_mfma_f32_32x32x16_bf16 v[192:207], v[250:253], v[212:215], v[192:207]
    s_waitcnt lgkmcnt(4)
    v_mfma_f32_32x32x16_bf16 v[176:191], v[32:35], v[128:131], v[176:191]
    ds_read_b64_tr_b16 v[144:145], v11 offset:8192
    ds_read_b64_tr_b16 v[146:147], v11 offset:8448
    v_mfma_f32_32x32x16_bf16 v[176:191], v[36:39], v[132:135], v[176:191]
    ds_read_b64_tr_b16 v[148:149], v11 offset:9216
    ds_read_b64_tr_b16 v[150:151], v11 offset:9472
    s_waitcnt lgkmcnt(4)
    v_mfma_f32_32x32x16_bf16 v[176:191], v[40:43], v[136:139], v[176:191]
    ds_read_b64_tr_b16 v[152:153], v11 offset:10240
    ds_read_b64_tr_b16 v[154:155], v11 offset:10496
    s_nop 0
    v_max3_f32 v160, v192, v193, v194
    v_min3_f32 v161, v192, v193, v194
    v_max3_f32 v160, v160, v195, v196
    v_min3_f32 v161, v161, v195, v196
    v_mfma_f32_32x32x16_bf16 v[176:191], v[44:47], v[140:143], v[176:191]
    s_add_u32 m0, s71, 45056
    s_add_u32 s91, s68, s61
    buffer_load_dwordx4 v10, s[32:35], s91 offen lds
    ds_read_b64_tr_b16 v[156:157], v11 offset:11264
    ds_read_b64_tr_b16 v[158:159], v11 offset:11520
    v_max3_f32 v160, v160, v197, v198
    v_min3_f32 v161, v161, v197, v198
    v_max3_f32 v160, v160, v199, v200
    v_min3_f32 v161, v161, v199, v200
    s_waitcnt lgkmcnt(4)
    v_mfma_f32_32x32x16_bf16 v[176:191], v[48:51], v[144:147], v[176:191]
    s_waitcnt vmcnt(8)
    s_barrier
    ds_read_b64_tr_b16 v[128:129], v11 offset:12288
    ds_read_b64_tr_b16 v[130:131], v11 offset:12544
    v_max3_f32 v160, v160, v201, v202
    v_min3_f32 v161, v161, v201, v202
    v_max3_f32 v160, v160, v203, v204
    v_min3_f32 v161, v161, v203, v204
    v_mfma_f32_32x32x16_bf16 v[176:191], v[52:55], v[148:151], v[176:191]
    ds_read_b64_tr_b16 v[132:133], v11 offset:13312
    ds_read_b64_tr_b16 v[134:135], v11 offset:13568
    v_max3_f32 v160, v160, v205, v206
    v_min3_f32 v161, v161, v205, v206
    v_max_f32 v160, v160, v207
    v_max_f32 v161, -v161, -v207
    s_waitcnt lgkmcnt(4)
    v_mfma_f32_32x32x16_bf16 v[176:191], v[56:59], v[152:155], v[176:191]
    s_add_u32 m0, s71, 49152
    s_add_u32 s91, s69, s61
    buffer_load_dwordx4 v10, s[32:35], s91 offen lds
    ds_read_b64_tr_b16 v[136:137], v11 offset:14336
    ds_read_b64_tr_b16 v[138:139], v11 offset:14592
    v_permlane32_swap_b32 v160, v161
    v_max_f32 v160, v160, v161
    v_mul_f32 v161, 0xbfb8aa3b, v160
    v_mul_f32 v160, 0xbfb8aa3b, v160
    s_nop 1
    v_permlane32_swap_b32 v160, v161
    s_nop 0
    v_pk_fma_f32 v[208:209], v[192:193], s[84:85], v[160:161] op_sel:[0,0,1] op_sel_hi:[1,0,1] neg_lo:[1,0,0] neg_hi:[1,0,0]
    v_pk_fma_f32 v[192:193], v[192:193], s[84:85], v[160:161] op_sel_hi:[1,0,0]
    v_pk_fma_f32 v[210:211], v[194:195], s[84:85], v[160:161] op_sel:[0,0,1] op_sel_hi:[1,0,1] neg_lo:[1,0,0] neg_hi:[1,0,0]
    v_pk_fma_f32 v[194:195], v[194:195], s[84:85], v[160:161] op_sel_hi:[1,0,0]
    v_pk_fma_f32 v[212:213], v[196:197], s[84:85], v[160:161] op_sel:[0,0,1] op_sel_hi:[1,0,1] neg_lo:[1,0,0] neg_hi:[1,0,0]
    v_pk_fma_f32 v[196:197], v[196:197], s[84:85], v[160:161] op_sel_hi:[1,0,0]
    v_pk_fma_f32 v[214:215], v[198:199], s[84:85], v[160:161] op_sel:[0,0,1] op_sel_hi:[1,0,1] neg_lo:[1,0,0] neg_hi:[1,0,0]
    v_pk_fma_f32 v[198:199], v[198:199], s[84:85], v[160:161] op_sel_hi:[1,0,0]
    v_pk_fma_f32 v[216:217], v[200:201], s[84:85], v[160:161] op_sel:[0,0,1] op_sel_hi:[1,0,1] neg_lo:[1,0,0] neg_hi:[1,0,0]
    v_pk_fma_f32 v[200:201], v[200:201], s[84:85], v[160:161] op_sel_hi:[1,0,0]
    v_pk_fma_f32 v[218:219], v[202:203], s[84:85], v[160:161] op_sel:[0,0,1] op_sel_hi:[1,0,1] neg_lo:[1,0,0] neg_hi:[1,0,0]
    v_pk_fma_f32 v[202:203], v[202:203], s[84:85], v[160:161] op_sel_hi:[1,0,0]
    v_pk_fma_f32 v[220:221], v[204:205], s[84:85], v[160:161] op_sel:[0,0,1] op_sel_hi:[1,0,1] neg_lo:[1,0,0] neg_hi:[1,0,0]
    v_pk_fma_f32 v[204:205], v[204:205], s[84:85], v[160:161] op_sel_hi:[1,0,0]
    v_pk_fma_f32 v[222:223], v[206:207], s[84:85], v[160:161] op_sel:[0,0,1] op_sel_hi:[1,0,1] neg_lo:[1,0,0] neg_hi:[1,0,0]
    v_pk_fma_f32 v[206:207], v[206:207], s[84:85], v[160:161] op_sel_hi:[1,0,0]
    v_mfma_f32_32x32x16_bf16 v[176:191], v[60:63], v[156:159], v[176:191]
    ds_read_b64_tr_b16 v[140:141], v11 offset:15360
    ds_read_b64_tr_b16 v[142:143], v11 offset:15616
    v_exp_f32 v192, v192
    v_exp_f32 v208, v208
    v_exp_f32 v193, v193
    s_waitcnt lgkmcnt(4)
    v_mfma_f32_32x32x16_bf16 v[176:191], v[64:67], v[128:131], v[176:191]
    ds_read_b64_tr_b16 v[144:145], v11 offset:16384
    ds_read_b64_tr_b16 v[146:147], v11 offset:16640
    v_exp_f32 v209, v209
    v_exp_f32 v194, v194
    v_exp_f32 v210, v210
    v_mfma_f32_32x32x16_bf16 v[176:191], v[68:71], v[132:135], v[176:191]
    s_add_u32 m0, s71, 53248
    s_add_u32 s91, s70, s61
    buffer_load_dwordx4 v10, s[32:35], s91 offen lds
    ds_read_b64_tr_b16 v[148:149], v11 offset:17408
    ds_read_b64_tr_b16 v[150:151], v11 offset:17664
    v_exp_f32 v195, v195
    v_exp_f32 v211, v211
    v_exp_f32 v196, v196
    s_waitcnt lgkmcnt(4)
    v_mfma_f32_32x32x16_bf16 v[176:191], v[72:75], v[136:139], v[176:191]
    ds_read_b64_tr_b16 v[152:153], v11 offset:18432
    ds_read_b64_tr_b16 v[154:155], v11 offset:18688
    v_exp_f32 v212, v212
    v_exp_f32 v197, v197
    v_exp_f32 v213, v213
    v_mfma_f32_32x32x16_bf16 v[176:191], v[76:79], v[140:143], v[176:191]
    s_add_u32 m0, s100, 57344
    s_nop 0
    buffer_load_dwordx4 v240, s[48:51], s8 offen offset:0 lds
    ds_read_b64_tr_b16 v[156:157], v11 offset:19456
    ds_read_b64_tr_b16 v[158:159], v11 offset:19712
    v_exp_f32 v198, v198
    v_exp_f32 v214, v214
    v_exp_f32 v199, v199
    s_waitcnt lgkmcnt(4)
    v_mfma_f32_32x32x16_bf16 v[176:191], v[80:83], v[144:147], v[176:191]
    s_waitcnt vmcnt(9)
    s_barrier
    ds_read_b64_tr_b16 v[128:129], v11 offset:20480
    ds_read_b64_tr_b16 v[130:131], v11 offset:20736
    v_exp_f32 v215, v215
    v_exp_f32 v200, v200
    v_exp_f32 v216, v216
    v_mfma_f32_32x32x16_bf16 v[176:191], v[84:87], v[148:151], v[176:191]
    ds_read_b64_tr_b16 v[132:133], v11 offset:21504
    ds_read_b64_tr_b16 v[134:135], v11 offset:21760
    v_exp_f32 v201, v201
    v_exp_f32 v217, v217
    v_exp_f32 v202, v202
    s_waitcnt lgkmcnt(4)
    v_mfma_f32_32x32x16_bf16 v[176:191], v[88:91], v[152:155], v[176:191]
    buffer_load_dwordx4 v241, s[48:51], s8 offen offset:1024 lds
    ds_read_b64_tr_b16 v[136:137], v11 offset:22528
    ds_read_b64_tr_b16 v[138:139], v11 offset:22784
    v_exp_f32 v218, v218
    v_exp_f32 v203, v203
    v_exp_f32 v219, v219
    v_mfma_f32_32x32x16_bf16 v[176:191], v[92:95], v[156:159], v[176:191]
    ds_read_b64_tr_b16 v[140:141], v11 offset:23552
    ds_read_b64_tr_b16 v[142:143], v11 offset:23808
    v_exp_f32 v204, v204
    v_exp_f32 v220, v220
    v_exp_f32 v205, v205
    s_waitcnt lgkmcnt(4)
    v_mfma_f32_32x32x16_bf16 v[176:191], v[96:99], v[128:131], v[176:191]
    buffer_load_dwordx4 v242, s[48:51], s8 offen offset:2048 lds
    ds_read_b64_tr_b16 v[144:145], v11 offset:24576
    ds_read_b64_tr_b16 v[146:147], v11 offset:24832
    v_exp_f32 v221, v221
    v_exp_f32 v206, v206
    v_exp_f32 v222, v222
    v_exp_f32 v207, v207
    v_exp_f32_e64 v223, v223
    v_pk_add_f32 v[164:165], v[192:193], v[194:195]
    v_pk_add_f32 v[166:167], v[208:209], v[210:211]
    v_pk_add_f32 v[164:165], v[164:165], v[196:197]
    v_pk_add_f32 v[166:167], v[166:167], v[212:213]
    v_pk_add_f32 v[164:165], v[164:165], v[198:199]
    v_pk_add_f32 v[166:167], v[166:167], v[214:215]
    v_pk_add_f32 v[164:165], v[164:165], v[200:201]
    v_pk_add_f32 v[166:167], v[166:167], v[216:217]
    v_pk_add_f32 v[164:165], v[164:165], v[202:203]
    v_pk_add_f32 v[166:167], v[166:167], v[218:219]
    v_pk_add_f32 v[168:169], v[204:205], v[206:207]
    v_pk_add_f32 v[170:171], v[220:221], v[222:223]
    v_pk_fma_f32 v[164:165], v[168:169], v[14:15], v[164:165] op_sel_hi:[1,0,1]
    v_pk_fma_f32 v[166:167], v[170:171], v[14:15], v[166:167] op_sel_hi:[1,0,1]
    v_add_f32 v160, v164, v165
    v_add_f32 v161, v166, v167
    s_nop 1
    v_permlane32_swap_b32 v160, v161
    v_add_f32 v160, v160, v161
    v_rcp_f32 v160, v160
    s_nop 0
    v_mul_f32 v161, v160, v4
    v_mul_f32 v160, v160, v4
    s_nop 1
    v_permlane32_swap_b32 v160, v161
    s_nop 0
    v_pk_mul_f32 v[192:193], v[192:193], v[160:161] op_sel_hi:[1,0]
    v_pk_mul_f32 v[194:195], v[194:195], v[160:161] op_sel_hi:[1,0]
    v_pk_mul_f32 v[196:197], v[196:197], v[160:161] op_sel_hi:[1,0]
    v_pk_mul_f32 v[198:199], v[198:199], v[160:161] op_sel_hi:[1,0]
    v_pk_mul_f32 v[200:201], v[200:201], v[160:161] op_sel_hi:[1,0]
    v_pk_mul_f32 v[202:203], v[202:203], v[160:161] op_sel_hi:[1,0]
    v_pk_mul_f32 v[204:205], v[204:205], v[160:161] op_sel_hi:[1,0]
    v_pk_mul_f32 v[206:207], v[206:207], v[160:161] op_sel_hi:[1,0]
    v_pk_mul_f32 v[208:209], v[208:209], v[160:161] op_sel:[0,1] op_sel_hi:[1,1]
    v_pk_mul_f32 v[210:211], v[210:211], v[160:161] op_sel:[0,1] op_sel_hi:[1,1]
    v_pk_mul_f32 v[212:213], v[212:213], v[160:161] op_sel:[0,1] op_sel_hi:[1,1]
    v_pk_mul_f32 v[214:215], v[214:215], v[160:161] op_sel:[0,1] op_sel_hi:[1,1]
    v_pk_mul_f32 v[216:217], v[216:217], v[160:161] op_sel:[0,1] op_sel_hi:[1,1]
    v_pk_mul_f32 v[218:219], v[218:219], v[160:161] op_sel:[0,1] op_sel_hi:[1,1]
    v_pk_mul_f32 v[220:221], v[220:221], v[160:161] op_sel:[0,1] op_sel_hi:[1,1]
    v_pk_mul_f32 v[222:223], v[222:223], v[160:161] op_sel:[0,1] op_sel_hi:[1,1]
    v_mfma_f32_32x32x16_bf16 v[176:191], v[100:103], v[132:135], v[176:191]
    buffer_load_dwordx4 v245, s[48:51], s8 offen offset:3072 lds
    ds_read_b64_tr_b16 v[148:149], v11 offset:25600
    ds_read_b64_tr_b16 v[150:151], v11 offset:25856
    v_cvt_pk_bf16_f32 v224, v192, v193
    v_cvt_pk_bf16_f32 v225, v194, v195
    v_cvt_pk_bf16_f32 v226, v196, v197
    v_cvt_pk_bf16_f32 v227, v198, v199
    s_waitcnt lgkmcnt(4)
    s_nop 0
    v_mfma_f32_32x32x16_bf16 v[176:191], v[104:107], v[136:139], v[176:191]
    ds_read_b64_tr_b16 v[152:153], v11 offset:26624
    ds_read_b64_tr_b16 v[154:155], v11 offset:26880
    ds_write_b128 v6, v[224:227] offset:0
    v_mfma_f32_32x32x16_bf16 v[176:191], v[108:111], v[140:143], v[176:191]
    s_add_u32 m0, s100, 61440
    s_add_u32 s91, s8, 57344
    buffer_load_dwordx4 v240, s[48:51], s91 offen offset:0 lds
    ds_read_b64_tr_b16 v[156:157], v11 offset:27648
    ds_read_b64_tr_b16 v[158:159], v11 offset:27904
    v_cvt_pk_bf16_f32 v228, v200, v201
    v_cvt_pk_bf16_f32 v229, v202, v203
    v_cvt_pk_bf16_f32 v230, v204, v205
    v_cvt_pk_bf16_f32 v231, v206, v207
    v_and_b32 v230, v230, v13
    v_and_b32 v231, v231, v13
    s_waitcnt lgkmcnt(5)
    s_nop 0
    v_mfma_f32_32x32x16_bf16 v[176:191], v[112:115], v[144:147], v[176:191]
    ds_write_b128 v6, v[228:231] offset:1152
    v_cvt_pk_bf16_f32 v232, v208, v209
    v_cvt_pk_bf16_f32 v233, v210, v211
    v_cvt_pk_bf16_f32 v234, v212, v213
    v_cvt_pk_bf16_f32 v235, v214, v215
    v_mfma_f32_32x32x16_bf16 v[176:191], v[116:119], v[148:151], v[176:191]
    buffer_load_dwordx4 v241, s[48:51], s91 offen offset:1024 lds
    ds_write_b128 v6, v[232:235] offset:2304
    s_waitcnt lgkmcnt(2)
    v_mfma_f32_32x32x16_bf16 v[176:191], v[120:123], v[152:155], v[176:191]
    v_cvt_pk_bf16_f32 v236, v216, v217
    v_cvt_pk_bf16_f32 v237, v218, v219
    v_cvt_pk_bf16_f32 v238, v220, v221
    v_cvt_pk_bf16_f32 v239, v222, v223
    v_and_b32 v238, v238, v13
    v_and_b32 v239, v239, v13
    v_mfma_f32_32x32x16_bf16 v[176:191], v[124:127], v[156:159], v[176:191]
    buffer_load_dwordx4 v242, s[48:51], s91 offen offset:2048 lds
    ds_write_b128 v6, v[236:239] offset:3456
    s_nop 9
    v_cvt_pk_bf16_f32 v176, v176, v177
    v_cvt_pk_bf16_f32 v177, v178, v179
    v_cvt_pk_bf16_f32 v178, v180, v181
    v_cvt_pk_bf16_f32 v179, v182, v183
    ds_write_b128 v7, v[176:179] offset:4608
    v_cvt_pk_bf16_f32 v180, v184, v185
    v_cvt_pk_bf16_f32 v181, v186, v187
    v_cvt_pk_bf16_f32 v182, v188, v189
    v_cvt_pk_bf16_f32 v183, v190, v191
    ds_write_b128 v7, v[180:183] offset:5632
    ds_write_b16 v3, v5
    s_movk_i32 s26, 896
    s_waitcnt lgkmcnt(0)
    s_barrier
    s_nop 0
    ds_read_b64_tr_b16 v[128:129], v8 offset:0
    ds_read_b64_tr_b16 v[130:131], v8 offset:128
    ds_read_b128 v[192:195], v9 offset:0
    ds_read_b128 v[196:199], v9 offset:256
    ds_read_b64_tr_b16 v[132:133], v8 offset:6656
    ds_read_b64_tr_b16 v[134:135], v8 offset:6784
    ds_read_b128 v[200:203], v9 offset:6656
    ds_read_b128 v[204:207], v9 offset:6912
    ds_read_b64_tr_b16 v[136:137], v8 offset:13312
    ds_read_b64_tr_b16 v[138:139], v8 offset:13440
    ds_read_b128 v[208:211], v9 offset:13312
    ds_read_b128 v[212:215], v9 offset:13568
    ds_read_b64_tr_b16 v[140:141], v8 offset:19968
    ds_read_b64_tr_b16 v[142:143], v8 offset:20096
    ds_read_b128 v[216:219], v9 offset:19968
    ds_read_b128 v[220:223], v9 offset:20224
    s_waitcnt vmcnt(11)
    v_readfirstlane_b32 s88, v15
    s_nop 0
    s_and_b32 s12, s88, 0xffff
    s_cmp_lt_u32 s12, 49
    s_cbranch_scc1 L_slow_5
L_back_6:
    s_cmp_ge_u32 s88, 196608
    s_cselect_b32 s14, 8192, 0
    s_xor_b32 s90, s90, s14
    v_lshrrev_b32 v2, 4, v0
    s_waitcnt lgkmcnt(13)
    v_mfma_f32_16x16x32_bf16 v[176:179], v[128:131], v[192:195], 0
    v_lshlrev_b32 v3, 2, v2
    v_xor_b32 v3, v3, v0
    s_waitcnt lgkmcnt(12)
    v_mfma_f32_16x16x32_bf16 v[180:183], v[128:131], v[196:199], 0
    v_and_b32 v190, 7, v3
    s_waitcnt lgkmcnt(9)
    v_mfma_f32_16x16x32_bf16 v[176:179], v[132:135], v[200:203], v[176:179]
    v_lshlrev_b32 v190, 4, v190
    v_mad_u32_u24 v190, v2, s26, v190
    s_waitcnt lgkmcnt(8)
    v_mfma_f32_16x16x32_bf16 v[180:183], v[132:135], v[204:207], v[180:183]
    v_bfe_u32 v191, v3, 3, 1
    v_mul_u32_u24 v2, 100352, v191
    s_waitcnt lgkmcnt(5)
    v_mfma_f32_16x16x32_bf16 v[176:179], v[136:139], v[208:211], v[176:179]
    v_add_u32 v2, v2, v190
    s_waitcnt lgkmcnt(4)
    v_mfma_f32_16x16x32_bf16 v[180:183], v[136:139], v[212:215], v[180:183]
    v_and_b32 v184, s58, v2
    v_add_u32 v185, 2560, v184
    s_waitcnt lgkmcnt(1)
    v_mfma_f32_16x16x32_bf16 v[176:179], v[140:143], v[216:219], v[176:179]
    v_add_u32 v186, 5120, v184
    v_add_u32 v187, 7680, v184
    s_waitcnt lgkmcnt(0)
    v_mfma_f32_16x16x32_bf16 v[180:183], v[140:143], v[220:223], v[180:183]
    s_nop 3
    v_cvt_pk_bf16_f32 v176, v176, v177
    v_cvt_pk_bf16_f32 v177, v178, v179
    s_nop 1
    v_cvt_pk_bf16_f32 v178, v180, v181
    v_cvt_pk_bf16_f32 v179, v182, v183
    buffer_store_dwordx4 v[176:179], v1, s[40:43], s90 offen sc1
    s_waitcnt vmcnt(11)
    s_barrier
    s_nop 0
    ds_read_b64_tr_b16 v[128:129], v11 offset:28672
    ds_read_b64_tr_b16 v[130:131], v11 offset:28928
    ds_read_b64_tr_b16 v[132:133], v11 offset:29696
    ds_read_b64_tr_b16 v[134:135], v11 offset:29952
    ds_read_b64_tr_b16 v[136:137], v11 offset:30720
    ds_read_b64_tr_b16 v[138:139], v11 offset:30976
    ds_read_b64_tr_b16 v[140:141], v11 offset:31744
    ds_read_b64_tr_b16 v[142:143], v11 offset:32000
    ds_read_b64_tr_b16 v[144:145], v11 offset:32768
    ds_read_b64_tr_b16 v[146:147], v11 offset:33024
    ds_read_b64_tr_b16 v[148:149], v11 offset:33792
    ds_read_b64_tr_b16 v[150:151], v11 offset:34048
    s_waitcnt lgkmcnt(10)
    v_mfma_f32_32x32x16_bf16 v[160:175], v[128:131], v[16:19], 0
    s_add_u32 m0, s100, 86016
    s_nop 0
    buffer_load_dwordx4 v184, s[44:47], s4 offen offset:0 lds
    ds_read_b64_tr_b16 v[152:153], v11 offset:34816
    ds_read_b64_tr_b16 v[154:155], v11 offset:35072
    ds_read_b64_tr_b16 v[156:157], v11 offset:35840
    ds_read_b64_tr_b16 v[158:159], v11 offset:36096
    s_waitcnt lgkmcnt(12)
    v_mfma_f32_32x32x16_bf16 v[160:175], v[132:135], v[20:23], v[160:175]
    ds_read_b64_tr_b16 v[192:193], v11 offset:36864
    ds_read_b64_tr_b16 v[194:195], v11 offset:37120
    ds_read_b64_tr_b16 v[196:197], v11 offset:37888
    ds_read_b64_tr_b16 v[198:199], v11 offset:38144
    v_bfe_u32 v2, v0, 2, 2
    s_waitcnt lgkmcnt(12)
    v_mfma_f32_32x32x16_bf16 v[160:175], v[136:139], v[24:27], v[160:175]
    buffer_load_dwordx4 v185, s[44:47], s4 offen offset:1024 lds
    ds_read_b64_tr_b16 v[200:201], v11 offset:38912
    ds_read_b64_tr_b16 v[202:203], v11 offset:39168
    ds_read_b64_tr_b16 v[204:205], v11 offset:39936
    ds_read_b64_tr_b16 v[206:207], v11 offset:40192
    v_xor_b32 v3, s3, v2
    v_mfma_f32_32x32x16_bf16 v[160:175], v[140:143], v[28:31], v[160:175]
    ds_read_b64_tr_b16 v[208:209], v11 offset:40960
    ds_read_b64_tr_b16 v[210:211], v11 offset:41216
    ds_read_b64_tr_b16 v[212:213], v11 offset:41984
    ds_read_b64_tr_b16 v[214:215], v11 offset:42240
    v_lshlrev_b32 v3, 6, v3
    s_waitcnt lgkmcnt(15)
    s_nop 0
    v_mfma_f32_32x32x16_bf16 v[160:175], v[144:147], v[32:35], v[160:175]
    buffer_load_dwordx4 v186, s[44:47], s4 offen offset:2048 lds
    ds_read_b64_tr_b16 v[216:217], v11 offset:43008
    ds_read_b64_tr_b16 v[218:219], v11 offset:43264
    ds_read_b64_tr_b16 v[220:221], v11 offset:44032
    ds_read_b64_tr_b16 v[222:223], v11 offset:44288
    v_lshl_add_u32 v3, v2, 8, v3
    v_mfma_f32_32x32x16_bf16 v[160:175], v[148:151], v[36:39], v[160:175]
    ds_read_b64_tr_b16 v[246:247], v244 offset:2048
    ds_read_b64_tr_b16 v[248:249], v244 offset:2496
    ds_read_b64_tr_b16 v[250:251], v244 offset:2944
    ds_read_b64_tr_b16 v[252:253], v244 offset:3392
    v_bfe_u32 v2, v0, 4, 1
    s_waitcnt lgkmcnt(15)
    v_mfma_f32_32x32x16_bf16 v[160:175], v[152:155], v[40:43], v[160:175]
    buffer_load_dwordx4 v187, s[44:47], s4 offen offset:3072 lds
    v_lshl_add_u32 v3, v2, 5, v3
    v_and_b32 v2, 3, v0
    v_lshl_add_u32 v3, v2, 3, v3
    v_lshrrev_b32 v2, 5, v0
    v_lshl_add_u32 v6, v2, 10, v3
    v_mfma_f32_32x32x16_bf16 v[160:175], v[156:159], v[44:47], v[160:175]
    v_add_u32 v7, 57344, v6
    v_add_u32 v10, 114688, v6
    s_and_b32 s12, s3, 2
    s_lshl_b32 s12, s12, 6
    v_xor_b32 v8, s12, v3
    v_mfma_f32_32x32x16_bf16 v[160:175], v[192:195], v[48:51], v[160:175]
    s_add_u32 m0, s100, 90112
    s_add_u32 s91, s4, 14336
    buffer_load_dwordx4 v184, s[44:47], s91 offen offset:0 lds
    s_waitcnt vmcnt(13)
    s_barrier
    ds_read_b64_tr_b16 v[128:129], v11 offset:45056
    ds_read_b64_tr_b16 v[130:131], v11 offset:45312
    ds_read_b64_tr_b16 v[132:133], v11 offset:46080
    ds_read_b64_tr_b16 v[134:135], v11 offset:46336
    v_mfma_f32_32x32x16_bf16 v[160:175], v[196:199], v[52:55], v[160:175]
    ds_read_b64_tr_b16 v[136:137], v11 offset:47104
    ds_read_b64_tr_b16 v[138:139], v11 offset:47360
    ds_read_b64_tr_b16 v[140:141], v11 offset:48128
    ds_read_b64_tr_b16 v[142:143], v11 offset:48384
    v_add_u32 v8, 86016, v8
    s_waitcnt lgkmcnt(15)
    s_nop 0
    v_mfma_f32_32x32x16_bf16 v[160:175], v[200:203], v[56:59], v[160:175]
    buffer_load_dwordx4 v185, s[44:47], s91 offen offset:1024 lds
    ds_read_b64_tr_b16 v[144:145], v11 offset:49152
    ds_read_b64_tr_b16 v[146:147], v11 offset:49408
    ds_read_b64_tr_b16 v[148:149], v11 offset:50176
    ds_read_b64_tr_b16 v[150:151], v11 offset:50432
    v_lshl_add_u32 v12, v2, 10, v8
    v_mfma_f32_32x32x16_bf16 v[160:175], v[204:207], v[60:63], v[160:175]
    ds_read_b64_tr_b16 v[152:153], v11 offset:51200
    ds_read_b64_tr_b16 v[154:155], v11 offset:51456
    ds_read_b64_tr_b16 v[156:157], v11 offset:52224
    ds_read_b64_tr_b16 v[158:159], v11 offset:52480
    v_xor_b32 v188, 128, v12
    v_mfma_f32_32x32x16_bf16 v[160:175], v[208:211], v[64:67], v[160:175]
    buffer_load_dwordx4 v186, s[44:47], s91 offen offset:2048 lds
    ds_read_b64_tr_b16 v[192:193], v11 offset:53248
    ds_read_b64_tr_b16 v[194:195], v11 offset:53504
    ds_read_b64_tr_b16 v[196:197], v11 offset:54272
    ds_read_b64_tr_b16 v[198:199], v11 offset:54528
    v_xor_b32 v9, 128, v8
L_pad2:
    s_cbranch_execz L_body
    v_mfma_f32_32x32x16_bf16 v[160:175], v[212:215], v[68:71], v[160:175]
    ds_read_b64_tr_b16 v[200:201], v11 offset:55296
    ds_read_b64_tr_b16 v[202:203], v11 offset:55552
    ds_read_b64_tr_b16 v[204:205], v11 offset:56320
    ds_read_b64_tr_b16 v[206:207], v11 offset:56576
    v_and_b32 v2, 3, v0
    s_waitcnt lgkmcnt(15)
    v_mfma_f32_32x32x16_bf16 v[160:175], v[216:219], v[72:75], v[160:175]
    s_add_u32 m0, s100, 114688
    s_nop 0
    buffer_load_dwordx4 v184, s[44:47], s5 offen offset:0 lds
    v_xor_b32 v2, s3, v2
    v_lshlrev_b32 v2, 6, v2
    v_and_b32 v3, 31, v0
    v_lshl_add_u32 v2, v3, 8, v2
    v_mfma_f32_32x32x16_bf16 v[160:175], v[220:223], v[76:79], v[160:175]
    v_lshrrev_b32 v3, 5, v0
    v_lshl_add_u32 v2, v3, 3, v2
    v_add_u32 v189, 153600, v2
    v_mul_u32_u24 v191, 28672, v191
    v_add_u32 v190, v190, v191
    v_mfma_f32_32x32x16_bf16 v[160:175], v[128:131], v[80:83], v[160:175]
    buffer_load_dwordx4 v185, s[44:47], s5 offen offset:1024 lds
    v_add_u32 v191, 2560, v190
    s_and_b32 s14, s90, 8192
    s_and_b32 s12, s57, 7
    s_lshl_b32 s87, s12, 7
    s_add_u32 s87, s87, s14
    v_mfma_f32_32x32x16_bf16 v[160:175], v[132:135], v[84:87], v[160:175]
    s_waitcnt lgkmcnt(0)
    s_waitcnt vmcnt(9)
    s_barrier
    s_cmp_lg_u32 s3, 0
    s_cbranch_scc1 L_w0_7
    s_waitcnt lgkmcnt(0)
    s_mov_b32 s88, 0
    s_mov_b32 s37, 0
    s_atomic_add s99, s[24:25], s86 offset:0
    s_atomic_add s99, s[24:25], s86 offset:2048
    s_atomic_add s99, s[24:25], s86 offset:8192
    s_atomic_add s99, s[24:25], s86 offset:10240
L_w0_7:
    v_mfma_f32_32x32x16_bf16 v[160:175], v[136:139], v[88:91], v[160:175]
    buffer_load_dwordx4 v186, s[44:47], s5 offen offset:2048 lds
    s_add_u32 s12, s12, 1
    s_lshl_b32 s12, s12, 22
    s_add_u32 s15, s12, s14
    s_bfe_u32 s12, s73, 0x30002
    s_lshl_b32 s98, s12, 7
    v_mfma_f32_32x32x16_bf16 v[160:175], v[140:143], v[92:95], v[160:175]
    ds_read_b64_tr_b16 a[0:1], v7 offset:0
    ds_read_b64_tr_b16 a[2:3], v7 offset:2048
    s_add_u32 s98, s98, s14
    s_add_u32 s12, s12, 1
    s_lshl_b32 s12, s12, 22
    v_mfma_f32_32x32x16_bf16 v[160:175], v[144:147], v[96:99], v[160:175]
    buffer_load_dwordx4 v187, s[44:47], s5 offen offset:3072 lds
    ds_read_b64_tr_b16 a[4:5], v7 offset:4096
    s_add_u32 s16, s12, s14
    s_lshl_b32 s61, s85, 7
    s_add_u32 s61, s61, s14
    s_lshl_b32 s90, s85, 16
    v_mfma_f32_32x32x16_bf16 v[160:175], v[148:151], v[100:103], v[160:175]
    ds_read_b64_tr_b16 a[6:7], v7 offset:6144
    ds_read_b64_tr_b16 a[8:9], v7 offset:8192
    s_add_u32 s90, s90, s71
    s_add_u32 s90, s90, 65536
    s_lshl_b32 s27, s59, 14
    v_mfma_f32_32x32x16_bf16 v[160:175], v[152:155], v[104:107], v[160:175]
    s_add_u32 m0, s100, 118784
    s_add_u32 s91, s5, 14336
    buffer_load_dwordx4 v184, s[44:47], s91 offen offset:0 lds
    ds_read_b64_tr_b16 a[10:11], v7 offset:10240
    v_bfe_u32 v2, v0, 4, 1
    v_lshlrev_b32 v2, 9, v2
    v_mfma_f32_32x32x16_bf16 v[160:175], v[156:159], v[108:111], v[160:175]
    ds_read_b64_tr_b16 a[12:13], v7 offset:12288
    ds_read_b64_tr_b16 a[14:15], v7 offset:14336
    v_lshl_add_u32 v2, v3, 3, v2
    v_and_b32 v3, 15, v0
    v_lshl_add_u32 v3, v3, 4, v2
    v_mfma_f32_32x32x16_bf16 v[160:175], v[192:195], v[112:115], v[160:175]
    buffer_load_dwordx4 v185, s[44:47], s91 offen offset:1024 lds
    ds_read_b64_tr_b16 a[16:17], v7 offset:16384
    v_add_u32 v3, s71, v3
    v_add_u32 v3, 149504, v3
    v_add_u32 v2, 149504, v1
    v_mfma_f32_32x32x16_bf16 v[160:175], v[196:199], v[116:119], v[160:175]
    ds_read_b64_tr_b16 a[18:19], v7 offset:18432
    ds_read_b64_tr_b16 a[20:21], v7 offset:20480
    v_and_b32 v252, v252, v13
    v_and_b32 v253, v253, v13
    v_mfma_f32_32x32x16_bf16 v[160:175], v[200:203], v[120:123], v[160:175]
    buffer_load_dwordx4 v186, s[44:47], s91 offen offset:2048 lds
    ds_read_b64_tr_b16 a[22:23], v7 offset:22528
    s_cmp_lg_u32 s3, 0
    s_cbranch_scc1 L_w0_8
    s_and_b32 s36, s59, 1
    s_lshl_b32 s36, s36, 11
    s_add_u32 s36, s36, s61
    s_atomic_umax s88, s[24:25], s36 offset:0 glc
L_w0_8:
    v_mfma_f32_32x32x16_bf16 v[160:175], v[204:207], v[124:127], v[160:175]
    ds_read_b64_tr_b16 a[24:25], v7 offset:24576
    ds_read_b64_tr_b16 a[26:27], v7 offset:26624
    s_add_u32 m0, s100, 28672
    s_nop 0
    buffer_load_dwordx4 v240, s[48:51], s9 offen offset:0 lds
    v_lshrrev_b32 v128, 2, v0
    v_xor_b32 v128, v128, v0
    v_bfe_i32 v128, v128, 2, 1
    v_bfi_b32 v128, v128, 0, s83
    v_mov_b32 v129, v128
    v_mov_b32 v130, v128
    v_mov_b32_e64 v131, v128
    v_pk_mul_f32 v[160:161], v[160:161], v[4:5] op_sel_hi:[1,0]
    v_pk_mul_f32 v[162:163], v[162:163], v[4:5] op_sel_hi:[1,0]
    v_pk_mul_f32 v[164:165], v[164:165], v[4:5] op_sel_hi:[1,0]
    v_pk_mul_f32 v[166:167], v[166:167], v[4:5] op_sel_hi:[1,0]
    v_pk_mul_f32 v[168:169], v[168:169], v[4:5] op_sel_hi:[1,0]
    v_pk_mul_f32 v[170:171], v[170:171], v[4:5] op_sel_hi:[1,0]
    v_pk_mul_f32 v[172:173], v[172:173], v[4:5] op_sel_hi:[1,0]
    v_pk_mul_f32 v[174:175], v[174:175], v[4:5] op_sel_hi:[1,0]
    v_cvt_pk_bf16_f32 v208, v160, v161
    v_cvt_pk_bf16_f32 v209, v162, v163
    v_cvt_pk_bf16_f32 v210, v164, v165
    v_cvt_pk_bf16_f32 v211, v166, v167
    v_cvt_pk_bf16_f32 v212, v168, v169
    v_cvt_pk_bf16_f32 v213, v170, v171
    v_cvt_pk_bf16_f32 v214, v172, v173
    v_cvt_pk_bf16_f32 v215, v174, v175
    v_mfma_f32_32x32x16_bf16 v[192:207], v[246:249], v[208:211], 0
    buffer_load_dwordx4 v241, s[48:51], s9 offen offset:1024 lds
    v_mfma_f32_32x32x16_bf16 v[192:207], v[250:253], v[212:215], v[192:207]
    buffer_load_dwordx4 v242, s[48:51], s9 offen offset:2048 lds
    s_nop 10
    s_nop 0
    v_max3_f32 v160, v192, v193, v194
    v_min3_f32 v161, v192, v193, v194
    v_max3_f32 v160, v160, v195, v196
    v_min3_f32 v161, v161, v195, v196
    v_max3_f32 v160, v160, v197, v198
    v_min3_f32 v161, v161, v197, v198
    v_max3_f32 v160, v160, v199, v200
    buffer_load_dwordx4 v245, s[48:51], s9 offen offset:3072 lds
    v_min3_f32 v161, v161, v199, v200
    v_max3_f32 v160, v160, v201, v202
    v_min3_f32 v161, v161, v201, v202
    v_max3_f32 v160, v160, v203, v204
    v_min3_f32 v161, v161, v203, v204
    v_max3_f32 v160, v160, v205, v206
    v_min3_f32 v161, v161, v205, v206
    s_add_u32 m0, s100, 32768
    s_add_u32 s91, s9, 57344
    buffer_load_dwordx4 v240, s[48:51], s91 offen offset:0 lds
    v_max_f32 v160, v160, v207
    v_max_f32 v161, -v161, -v207
    s_nop 1
    v_permlane32_swap_b32 v160, v161
    v_max_f32 v160, v160, v161
    v_mul_f32 v161, 0xbfb8aa3b, v160
    v_mul_f32 v160, 0xbfb8aa3b, v160
    s_nop 1
    v_permlane32_swap_b32 v160, v161
    v_pk_fma_f32 v[208:209], v[192:193], s[84:85], v[160:161] op_sel:[0,0,1] op_sel_hi:[1,0,1] neg_lo:[1,0,0] neg_hi:[1,0,0]
    buffer_load_dwordx4 v241, s[48:51], s91 offen offset:1024 lds
    v_pk_fma_f32 v[192:193], v[192:193], s[84:85], v[160:161] op_sel_hi:[1,0,0]
    v_pk_fma_f32 v[210:211], v[194:195], s[84:85], v[160:161] op_sel:[0,0,1] op_sel_hi:[1,0,1] neg_lo:[1,0,0] neg_hi:[1,0,0]
    v_pk_fma_f32 v[194:195], v[194:195], s[84:85], v[160:161] op_sel_hi:[1,0,0]
    v_pk_fma_f32 v[212:213], v[196:197], s[84:85], v[160:161] op_sel:[0,0,1] op_sel_hi:[1,0,1] neg_lo:[1,0,0] neg_hi:[1,0,0]
    v_pk_fma_f32 v[196:197], v[196:197], s[84:85], v[160:161] op_sel_hi:[1,0,0]
    v_pk_fma_f32 v[214:215], v[198:199], s[84:85], v[160:161] op_sel:[0,0,1] op_sel_hi:[1,0,1] neg_lo:[1,0,0] neg_hi:[1,0,0]
    v_pk_fma_f32 v[198:199], v[198:199], s[84:85], v[160:161] op_sel_hi:[1,0,0]
    buffer_load_dwordx4 v242, s[48:51], s91 offen offset:2048 lds
    v_pk_fma_f32 v[216:217], v[200:201], s[84:85], v[160:161] op_sel:[0,0,1] op_sel_hi:[1,0,1] neg_lo:[1,0,0] neg_hi:[1,0,0]
    v_pk_fma_f32 v[200:201], v[200:201], s[84:85], v[160:161] op_sel_hi:[1,0,0]
    v_pk_fma_f32 v[218:219], v[202:203], s[84:85], v[160:161] op_sel:[0,0,1] op_sel_hi:[1,0,1] neg_lo:[1,0,0] neg_hi:[1,0,0]
    v_pk_fma_f32 v[202:203], v[202:203], s[84:85], v[160:161] op_sel_hi:[1,0,0]
    v_pk_fma_f32 v[220:221], v[204:205], s[84:85], v[160:161] op_sel:[0,0,1] op_sel_hi:[1,0,1] neg_lo:[1,0,0] neg_hi:[1,0,0]
    v_pk_fma_f32 v[204:205], v[204:205], s[84:85], v[160:161] op_sel_hi:[1,0,0]
    v_pk_fma_f32 v[222:223], v[206:207], s[84:85], v[160:161] op_sel:[0,0,1] op_sel_hi:[1,0,1] neg_lo:[1,0,0] neg_hi:[1,0,0]
    v_pk_fma_f32 v[206:207], v[206:207], s[84:85], v[160:161] op_sel_hi:[1,0,0]
    s_waitcnt vmcnt(7)
    s_waitcnt lgkmcnt(0)
    s_cmp_lg_u32 s3, 0
    s_cbranch_scc1 L_w0_11
    s_mov_b32 s89, 0
L_poll_9:
    s_waitcnt lgkmcnt(0)
    s_cmp_ge_u32 s88, 16
    s_cbranch_scc1 L_done_10
    s_atomic_umax s88, s[24:25], s36 offset:0 glc
    s_add_u32 s89, s89, 1
    s_cmp_lt_u32 s89, 131072
    s_cbranch_scc1 L_poll_9
L_done_10:
L_w0_11:
    s_barrier
    s_add_u32 s26, s90, s27
    s_add_u32 s27, s27, 16384
    s_and_b32 s27, s27, 0xffff
    buffer_load_dwordx4 v[16:19], v1, s[40:43], s26 offen sc1
    s_add_u32 s26, s26, 4096
    buffer_load_dwordx4 v[20:23], v1, s[40:43], s26 offen sc1
    s_add_u32 s26, s26, 4096
    buffer_load_dwordx4 v[24:27], v1, s[40:43], s26 offen sc1
    v_exp_f32 v192, v192
    v_exp_f32 v208, v208
    v_exp_f32 v193, v193
    v_exp_f32 v209, v209
    v_exp_f32 v194, v194
    v_exp_f32 v210, v210
    v_exp_f32 v195, v195
    v_exp_f32 v211, v211
    v_exp_f32 v196, v196
    s_add_u32 s26, s26, 4096
    buffer_load_dwordx4 v[28:31], v1, s[40:43], s26 offen sc1
    v_exp_f32 v212, v212
    v_exp_f32 v197, v197
    v_exp_f32 v213, v213
    v_exp_f32 v198, v198
    v_exp_f32 v214, v214
    v_exp_f32 v199, v199
    v_exp_f32 v215, v215
    v_exp_f32 v200, v200
    v_exp_f32 v216, v216
    s_add_u32 s26, s90, s27
    s_add_u32 s27, s27, 16384
    s_and_b32 s27, s27, 0xffff
    buffer_load_dwordx4 v[32:35], v1, s[40:43], s26 offen sc1
    v_exp_f32 v201, v201
    v_exp_f32 v217, v217
    v_exp_f32 v202, v202
    v_exp_f32 v218, v218
    v_exp_f32 v203, v203
    v_exp_f32 v219, v219
    v_exp_f32 v204, v204
    v_exp_f32 v220, v220
    v_exp_f32 v205, v205
    v_exp_f32 v221, v221
    s_add_u32 s26, s26, 4096
    buffer_load_dwordx4 v[36:39], v1, s[40:43], s26 offen sc1
    v_exp_f32 v206, v206
    v_exp_f32 v222, v222
    v_exp_f32 v207, v207
    v_exp_f32_e64 v223, v223
    v_pk_add_f32 v[164:165], v[192:193], v[194:195]
    v_pk_add_f32 v[166:167], v[208:209], v[210:211]
    v_pk_add_f32 v[164:165], v[164:165], v[196:197]
    v_pk_add_f32 v[166:167], v[166:167], v[212:213]
    v_pk_add_f32 v[164:165], v[164:165], v[198:199]
    s_add_u32 s26, s26, 4096
    buffer_load_dwordx4 v[40:43], v1, s[40:43], s26 offen sc1
    v_pk_add_f32 v[166:167], v[166:167], v[214:215]
    v_pk_add_f32 v[164:165], v[164:165], v[200:201]
    v_pk_add_f32 v[166:167], v[166:167], v[216:217]
    v_pk_add_f32 v[164:165], v[164:165], v[202:203]
    v_pk_add_f32 v[166:167], v[166:167], v[218:219]
    v_pk_add_f32 v[168:169], v[204:205], v[206:207]
    v_pk_add_f32 v[170:171], v[220:221], v[222:223]
    v_pk_fma_f32 v[164:165], v[168:169], v[14:15], v[164:165] op_sel_hi:[1,0,1]
    v_pk_fma_f32 v[166:167], v[170:171], v[14:15], v[166:167] op_sel_hi:[1,0,1]
    v_add_f32 v160, v164, v165
    s_add_u32 s26, s26, 4096
    buffer_load_dwordx4 v[44:47], v1, s[40:43], s26 offen sc1
    v_add_f32 v161, v166, v167
    s_nop 1
    v_permlane32_swap_b32 v160, v161
    v_add_f32 v160, v160, v161
    v_rcp_f32 v160, v160
    s_nop 0
    v_mov_b32 v161, v160
    s_nop 1
    v_permlane32_swap_b32 v160, v161
    v_pk_mul_f32 v[192:193], v[192:193], v[160:161] op_sel_hi:[1,0]
    v_pk_mul_f32 v[194:195], v[194:195], v[160:161] op_sel_hi:[1,0]
    v_pk_mul_f32 v[196:197], v[196:197], v[160:161] op_sel_hi:[1,0]
    s_add_u32 s26, s90, s27
    s_nop 0
    s_add_u32 s27, s27, 16384
    s_and_b32 s27, s27, 0xffff
    buffer_load_dwordx4 v[48:51], v1, s[40:43], s26 offen sc1
    v_pk_mul_f32 v[198:199], v[198:199], v[160:161] op_sel_hi:[1,0]
    v_cvt_pk_bf16_f32 v224, v192, v193
    v_cvt_pk_bf16_f32 v225, v194, v195
    v_cvt_pk_bf16_f32 v226, v196, v197
    v_cvt_pk_bf16_f32 v227, v198, v199
    v_pk_mul_f32 v[200:201], v[200:201], v[160:161] op_sel_hi:[1,0]
    v_pk_mul_f32 v[202:203], v[202:203], v[160:161] op_sel_hi:[1,0]
    v_pk_mul_f32 v[204:205], v[204:205], v[160:161] op_sel_hi:[1,0]
    v_pk_mul_f32 v[206:207], v[206:207], v[160:161] op_sel_hi:[1,0]
    v_cvt_pk_bf16_f32 v228, v200, v201
    s_add_u32 s26, s26, 4096
    buffer_load_dwordx4 v[52:55], v1, s[40:43], s26 offen sc1
    v_cvt_pk_bf16_f32 v229, v202, v203
    v_cvt_pk_bf16_f32 v230, v204, v205
    v_cvt_pk_bf16_f32 v231, v206, v207
    v_pk_mul_f32 v[208:209], v[208:209], v[160:161] op_sel:[0,1] op_sel_hi:[1,1]
    v_pk_mul_f32 v[210:211], v[210:211], v[160:161] op_sel:[0,1] op_sel_hi:[1,1]
    v_pk_mul_f32 v[212:213], v[212:213], v[160:161] op_sel:[0,1] op_sel_hi:[1,1]
    v_pk_mul_f32 v[214:215], v[214:215], v[160:161] op_sel:[0,1] op_sel_hi:[1,1]
    v_cvt_pk_bf16_f32 v232, v208, v209
    v_cvt_pk_bf16_f32 v233, v210, v211
    s_add_u32 s26, s26, 4096
    buffer_load_dwordx4 v[56:59], v1, s[40:43], s26 offen sc1
    v_cvt_pk_bf16_f32 v234, v212, v213
    v_cvt_pk_bf16_f32 v235, v214, v215
    v_pk_mul_f32 v[216:217], v[216:217], v[160:161] op_sel:[0,1] op_sel_hi:[1,1]
    v_pk_mul_f32 v[218:219], v[218:219], v[160:161] op_sel:[0,1] op_sel_hi:[1,1]
    v_pk_mul_f32 v[220:221], v[220:221], v[160:161] op_sel:[0,1] op_sel_hi:[1,1]
    v_pk_mul_f32 v[222:223], v[222:223], v[160:161] op_sel:[0,1] op_sel_hi:[1,1]
    v_cvt_pk_bf16_f32 v236, v216, v217
    v_cvt_pk_bf16_f32 v237, v218, v219
    v_cvt_pk_bf16_f32 v238, v220, v221
    v_cvt_pk_bf16_f32 v239, v222, v223
    s_waitcnt vmcnt(10)
    s_nop 0
    v_mfma_f32_16x16x32_bf16 v[96:99], a[252:255], v[16:19], 0
    v_mfma_f32_16x16x32_bf16 v[100:103], a[250:253], v[16:19], 0
    s_add_u32 s26, s26, 4096
    buffer_load_dwordx4 v[60:63], v1, s[40:43], s26 offen sc1
    ds_read_b64_tr_b16 a[112:113], v12 offset:0
    ds_read_b64_tr_b16 a[114:115], v12 offset:2048
    ds_read_b64_tr_b16 a[116:117], v12 offset:4096
    ds_read_b64_tr_b16 a[118:119], v8 offset:6144
    ds_read_b64_tr_b16 a[120:121], v12 offset:7168
    ds_read_b64_tr_b16 a[122:123], v12 offset:9216
    ds_read_b64_tr_b16 a[124:125], v12 offset:11264
    s_waitcnt vmcnt(10)
    v_mfma_f32_16x16x32_bf16 v[96:99], a[252:255], v[20:23], v[96:99]
    v_mfma_f32_16x16x32_bf16 v[100:103], a[250:253], v[20:23], v[100:103]
    s_add_u32 s26, s90, s27
    s_add_u32 s27, s27, 16384
    s_and_b32 s27, s27, 0xffff
    buffer_load_dwordx4 v[64:67], v1, s[40:43], s26 offen sc1
    ds_read_b64_tr_b16 a[126:127], v8 offset:13312
    ds_read_b64_tr_b16 a[128:129], v12 offset:14336
    ds_read_b64_tr_b16 a[130:131], v12 offset:16384
    ds_read_b64_tr_b16 a[132:133], v12 offset:18432
    ds_read_b64_tr_b16 a[134:135], v8 offset:20480
    ds_read_b64_tr_b16 a[136:137], v12 offset:21504
    ds_read_b64_tr_b16 a[138:139], v12 offset:23552
    ds_read_b64_tr_b16 a[140:141], v12 offset:25600
    s_waitcnt vmcnt(10)
    s_nop 0
    v_mfma_f32_16x16x32_bf16 v[96:99], a[252:255], v[24:27], v[96:99]
    v_mfma_f32_16x16x32_bf16 v[100:103], a[250:253], v[24:27], v[100:103]
    s_add_u32 s26, s26, 4096
    buffer_load_dwordx4 v[68:71], v1, s[40:43], s26 offen sc1
    ds_read_b64_tr_b16 a[142:143], v8 offset:27648
    ds_read_b64_tr_b16 a[144:145], v188 offset:0
    ds_read_b64_tr_b16 a[146:147], v188 offset:2048
    ds_read_b64_tr_b16 a[148:149], v188 offset:4096
    ds_read_b64_tr_b16 a[150:151], v9 offset:6144
    ds_read_b64_tr_b16 a[152:153], v188 offset:7168
    ds_read_b64_tr_b16 a[154:155], v188 offset:9216
    ds_read_b64_tr_b16 a[156:157], v188 offset:11264
    s_waitcnt vmcnt(10)
    s_nop 0
    v_mfma_f32_16x16x32_bf16 v[96:99], a[252:255], v[28:31], v[96:99]
    v_mfma_f32_16x16x32_bf16 v[100:103], a[250:253], v[28:31], v[100:103]
    s_add_u32 s26, s26, 4096
    buffer_load_dwordx4 v[72:75], v1, s[40:43], s26 offen sc1
    ds_read_b64_tr_b16 a[158:159], v9 offset:13312
    ds_read_b64_tr_b16 a[160:161], v188 offset:14336
    ds_read_b64_tr_b16 a[162:163], v188 offset:16384
    ds_read_b64_tr_b16 a[164:165], v188 offset:18432
    ds_read_b64_tr_b16 a[166:167], v9 offset:20480
    ds_read_b64_tr_b16 a[168:169], v188 offset:21504
    ds_read_b64_tr_b16 a[170:171], v188 offset:23552
    ds_read_b64_tr_b16 a[172:173], v188 offset:25600
    ds_read_b64_tr_b16 a[174:175], v9 offset:27648
    s_waitcnt vmcnt(10)
    s_nop 0
    v_mfma_f32_16x16x32_bf16 v[96:99], a[252:255], v[32:35], v[96:99]
    v_mfma_f32_16x16x32_bf16 v[100:103], a[250:253], v[32:35], v[100:103]
    s_add_u32 s26, s26, 4096
    buffer_load_dwordx4 v[76:79], v1, s[40:43], s26 offen sc1
    ds_read_b64_tr_b16 a[176:177], v12 offset:28672
    ds_read_b64_tr_b16 a[178:179], v12 offset:30720
    ds_read_b64_tr_b16 a[180:181], v12 offset:32768
    ds_read_b64_tr_b16 a[182:183], v8 offset:34816
    ds_read_b64_tr_b16 a[184:185], v12 offset:35840
    ds_read_b64_tr_b16 a[186:187], v12 offset:37888
    ds_read_b64_tr_b16 a[188:189], v12 offset:39936
    s_waitcnt vmcnt(10)
    v_mfma_f32_16x16x32_bf16 v[96:99], a[252:255], v[36:39], v[96:99]
    v_mfma_f32_16x16x32_bf16 v[100:103], a[250:253], v[36:39], v[100:103]
    s_lshl_b32 s91, s3, 11
    s_add_u32 m0, s91, 153600
    s_nop 0
    s_nop 0
    buffer_load_dwordx4 v190, s[28:31], s101 offen lds
    ds_read_b64_tr_b16 a[190:191], v8 offset:41984
    ds_read_b64_tr_b16 a[192:193], v12 offset:43008
    ds_read_b64_tr_b16 a[194:195], v12 offset:45056
    ds_read_b64_tr_b16 a[196:197], v12 offset:47104
    ds_read_b64_tr_b16 a[198:199], v8 offset:49152
    ds_read_b64_tr_b16 a[200:201], v12 offset:50176
    ds_read_b64_tr_b16 a[202:203], v12 offset:52224
    ds_read_b64_tr_b16 a[204:205], v12 offset:54272
    s_waitcnt vmcnt(10)
    s_nop 0
    v_mfma_f32_16x16x32_bf16 v[96:99], a[252:255], v[40:43], v[96:99]
    v_mfma_f32_16x16x32_bf16 v[100:103], a[250:253], v[40:43], v[100:103]
    buffer_load_dwordx4 v191, s[28:31], s101 offen offset:1024 lds
    ds_read_b64_tr_b16 a[206:207], v8 offset:56320
    ds_read_b64_tr_b16 a[208:209], v188 offset:28672
    ds_read_b64_tr_b16 a[210:211], v188 offset:30720
    ds_read_b64_tr_b16 a[212:213], v188 offset:32768
    ds_read_b64_tr_b16 a[214:215], v9 offset:34816
    ds_read_b64_tr_b16 a[216:217], v188 offset:35840
    ds_read_b64_tr_b16 a[218:219], v188 offset:37888
    ds_read_b64_tr_b16 a[220:221], v188 offset:39936
    s_waitcnt vmcnt(10)
    s_nop 0
    v_mfma_f32_16x16x32_bf16 v[96:99], a[252:255], v[44:47], v[96:99]
    v_mfma_f32_16x16x32_bf16 v[100:103], a[250:253], v[44:47], v[100:103]
    ds_read_b64_tr_b16 a[222:223], v9 offset:41984
    ds_read_b64_tr_b16 a[224:225], v188 offset:43008
    ds_read_b64_tr_b16 a[226:227], v188 offset:45056
    ds_read_b64_tr_b16 a[228:229], v188 offset:47104
    ds_read_b64_tr_b16 a[230:231], v9 offset:49152
    ds_read_b64_tr_b16 a[232:233], v188 offset:50176
    ds_read_b64_tr_b16 a[234:235], v188 offset:52224
    ds_read_b64_tr_b16 a[236:237], v188 offset:54272
    ds_read_b64_tr_b16 a[238:239], v9 offset:56320
    s_waitcnt vmcnt(9)
    v_mfma_f32_16x16x32_bf16 v[96:99], a[252:255], v[48:51], v[96:99]
    v_mfma_f32_16x16x32_bf16 v[100:103], a[250:253], v[48:51], v[100:103]
    s_add_u32 m0, s100, 0
    s_nop 0
    buffer_load_dwordx4 v240, s[52:55], s8 offen offset:0 lds
    s_waitcnt vmcnt(9)
    v_mfma_f32_16x16x32_bf16 v[96:99], a[252:255], v[52:55], v[96:99]
    v_mfma_f32_16x16x32_bf16 v[100:103], a[250:253], v[52:55], v[100:103]
    buffer_load_dwordx4 v241, s[52:55], s8 offen offset:1024 lds
    s_waitcnt vmcnt(9)
    v_mfma_f32_16x16x32_bf16 v[96:99], a[252:255], v[56:59], v[96:99]
    v_mfma_f32_16x16x32_bf16 v[100:103], a[250:253], v[56:59], v[100:103]
    s_waitcnt vmcnt(8)
    v_mfma_f32_16x16x32_bf16 v[96:99], a[252:255], v[60:63], v[96:99]
    v_mfma_f32_16x16x32_bf16 v[100:103], a[250:253], v[60:63], v[100:103]
    buffer_load_dwordx4 v242, s[52:55], s8 offen offset:2048 lds
    s_waitcnt vmcnt(8)
    v_mfma_f32_16x16x32_bf16 v[96:99], a[252:255], v[64:67], v[96:99]
    v_mfma_f32_16x16x32_bf16 v[100:103], a[250:253], v[64:67], v[100:103]
    buffer_load_dwordx4 v245, s[52:55], s8 offen offset:3072 lds
    s_waitcnt vmcnt(8)
    v_mfma_f32_16x16x32_bf16 v[96:99], a[252:255], v[68:71], v[96:99]
    v_mfma_f32_16x16x32_bf16 v[100:103], a[250:253], v[68:71], v[100:103]
    s_waitcnt vmcnt(7)
    v_mfma_f32_16x16x32_bf16 v[96:99], a[252:255], v[72:75], v[96:99]
    v_mfma_f32_16x16x32_bf16 v[100:103], a[250:253], v[72:75], v[100:103]
    s_add_u32 m0, s100, 4096
    s_add_u32 s91, s8, 57344
    buffer_load_dwordx4 v240, s[52:55], s91 offen offset:0 lds
    s_waitcnt vmcnt(7)
    v_mfma_f32_16x16x32_bf16 v[96:99], a[252:255], v[76:79], v[96:99]
    v_mfma_f32_16x16x32_bf16 v[100:103], a[250:253], v[76:79], v[100:103]
    s_lshr_b32 s26, s85, 2
    s_lshl2_add_u32 s26, s3, s26
    s_and_b32 s90, s85, 3
    s_lshl3_add_u32 s26, s26, s90
    s_lshl_b32 s26, s26, 11
    s_add_u32 s90, s26, s15
    s_nop 0
    v_cvt_pk_bf16_f32 v96, v96, v97
    v_cvt_pk_bf16_f32 v97, v98, v99
    v_cvt_pk_bf16_f32 v98, v100, v101
    v_cvt_pk_bf16_f32 v99, v102, v103
    ds_write_b64 v3, v[96:97]
    ds_write_b64 v3, v[98:99] offset:256
    s_waitcnt lgkmcnt(0)
    s_barrier
    ds_read_b128 v[16:19], v2 offset:0
    ds_read_b128 v[20:23], v2 offset:1024
    ds_read_b128 v[24:27], v2 offset:2048
    ds_read_b128 v[28:31], v2 offset:3072
    buffer_load_dwordx4 v241, s[52:55], s91 offen offset:1024 lds
    s_waitcnt lgkmcnt(3)
    v_mfma_f32_32x32x16_bf16 v[32:47], v[16:19], v[224:227], 0
    s_and_b32 s13, s3, 1
    s_lshl_b32 s13, s13, 12
    s_and_b32 s27, s73, 3
    s_waitcnt lgkmcnt(2)
    v_mfma_f32_32x32x16_bf16 v[32:47], v[20:23], v[228:231], v[32:47]
    s_lshl_b32 s27, s27, 16
    s_add_u32 s27, s27, s16
    s_add_u32 s27, s27, s13
    s_and_b32 s26, s60, 1
    s_waitcnt lgkmcnt(1)
    v_mfma_f32_32x32x16_bf16 v[32:47], v[24:27], v[232:235], v[32:47]
    s_lshl_b32 s26, s26, 15
    s_add_u32 s27, s27, s26
    s_xor_b32 s12, s27, 32768
    s_waitcnt lgkmcnt(0)
    v_mfma_f32_32x32x16_bf16 v[32:47], v[28:31], v[236:239], v[32:47]
    s_and_b32 s26, s3, 2
    s_lshl_b32 s26, s26, 14
    s_add_u32 s26, s26, 86016
    s_add_u32 s13, s13, s26
    s_nop 7
    v_add_f32 v2, 0x358637bd, v44
    v_rcp_f32 v2, v2
    s_nop 0
    v_mov_b32 v3, v2
    s_nop 1
    v_permlane32_swap_b32 v2, v3
    s_nop 0
    v_pk_mul_f32 v[32:33], v[32:33], v[2:3] op_sel:[0,1] op_sel_hi:[1,1]
    v_pk_mul_f32 v[34:35], v[34:35], v[2:3] op_sel:[0,1] op_sel_hi:[1,1]
    v_pk_mul_f32 v[36:37], v[36:37], v[2:3] op_sel:[0,1] op_sel_hi:[1,1]
    v_pk_mul_f32 v[38:39], v[38:39], v[2:3] op_sel:[0,1] op_sel_hi:[1,1]
    v_cvt_pk_bf16_f32 v16, v32, v33
    v_cvt_pk_bf16_f32 v17, v34, v35
    v_cvt_pk_bf16_f32 v18, v36, v37
    v_cvt_pk_bf16_f32 v19, v38, v39
    buffer_store_dwordx4 v[16:19], v1, s[40:43], s90 offen offset:0 sc1
    v_pk_mul_f32 v[40:41], v[40:41], v[2:3] op_sel:[0,1] op_sel_hi:[1,1]
    v_pk_mul_f32 v[42:43], v[42:43], v[2:3] op_sel:[0,1] op_sel_hi:[1,1]
    v_pk_mul_f32 v[44:45], v[44:45], v[2:3] op_sel:[0,1] op_sel_hi:[1,1]
    v_pk_mul_f32 v[46:47], v[46:47], v[2:3] op_sel:[0,1] op_sel_hi:[1,1]
    v_cvt_pk_bf16_f32 v20, v40, v41
    v_cvt_pk_bf16_f32 v21, v42, v43
    v_cvt_pk_bf16_f32 v22, v44, v45
    v_cvt_pk_bf16_f32 v23, v46, v47
    v_and_b32 v22, v22, v13
    v_and_b32 v23, v23, v13
    buffer_store_dwordx4 v[20:23], v1, s[40:43], s90 offen offset:1024 sc1
    v_add_u32 v2, s26, v1
    buffer_load_dwordx4 v242, s[52:55], s91 offen offset:2048 lds
    s_add_u32 m0, s100, 86016
    s_nop 0
    buffer_load_dwordx4 v240, s[48:51], s10 offen offset:0 lds
    s_waitcnt vmcnt(10)
    s_barrier
    buffer_load_dwordx4 v241, s[48:51], s10 offen offset:1024 lds
    ds_read_b64_tr_b16 a[28:29], v6 offset:28672
    buffer_load_dwordx4 v242, s[48:51], s10 offen offset:2048 lds
    ds_read_b64_tr_b16 a[30:31], v6 offset:30720
    ds_read_b64_tr_b16 a[32:33], v6 offset:32768
    ds_read_b64_tr_b16 a[34:35], v6 offset:34816
    buffer_load_dwordx4 v245, s[48:51], s10 offen offset:3072 lds
    ds_read_b64_tr_b16 a[36:37], v6 offset:36864
    ds_read_b64_tr_b16 a[38:39], v6 offset:38912
    ds_read_b64_tr_b16 a[40:41], v6 offset:40960
    s_add_u32 m0, s100, 90112
    s_add_u32 s91, s10, 57344
    buffer_load_dwordx4 v240, s[48:51], s91 offen offset:0 lds
    ds_read_b64_tr_b16 a[42:43], v6 offset:43008
    ds_read_b64_tr_b16 a[44:45], v6 offset:45056
    buffer_load_dwordx4 v241, s[48:51], s91 offen offset:1024 lds
    ds_read_b64_tr_b16 a[46:47], v6 offset:47104
    ds_read_b64_tr_b16 a[48:49], v6 offset:49152
    ds_read_b64_tr_b16 a[50:51], v6 offset:51200
    buffer_load_dwordx4 v242, s[48:51], s91 offen offset:2048 lds
    ds_read_b64_tr_b16 a[52:53], v6 offset:53248
    ds_read_b64_tr_b16 a[54:55], v6 offset:55296
    ds_read_b64 v[112:113], v189 offset:0
    s_add_u32 m0, s100, 57344
    s_nop 0
    buffer_load_dwordx4 v240, s[48:51], s11 offen offset:0 lds
    ds_read_b64 v[114:115], v189 offset:16
    ds_read_b64 v[116:117], v189 offset:32
    ds_read_b64 v[118:119], v189 offset:48
    s_waitcnt vmcnt(9)
    s_waitcnt lgkmcnt(0)
    s_barrier
    s_cmp_lg_u32 s3, 0
    s_cbranch_scc1 L_w0_12
    s_waitcnt lgkmcnt(0)
    s_mov_b32 s88, 0
    s_mov_b32 s37, 0
    s_atomic_add s99, s[24:25], s87 offset:16384
    s_atomic_add s99, s[24:25], s87 offset:17408
    s_atomic_add s99, s[24:25], s87 offset:18432
    s_atomic_add s99, s[24:25], s87 offset:19456
L_w0_12:
    s_cmp_lg_u32 s78, 0
    s_cbranch_scc1 L_idle
    buffer_load_dwordx4 v241, s[48:51], s11 offen offset:1024 lds
    s_mov_b64 s[32:33], s[18:19]
    s_mov_b32 s34, 1605632
    s_mov_b32 s35, 0x20000
    s_mov_b64 s[28:29], s[20:21]
    s_mov_b32 s30, 1835008
    buffer_load_dwordx4 v242, s[48:51], s11 offen offset:2048 lds
    s_mov_b32 s31, 0x20000
    s_lshl2_add_u32 s62, s79, s3
    s_mul_i32 s26, s62, 37
    s_lshr_b32 s26, s26, 8
    s_mul_i32 s26, s26, 9
    s_add_u32 s69, s26, s62
    buffer_load_dwordx4 v245, s[48:51], s11 offen offset:3072 lds
    s_lshl_b32 s69, s69, 10
    s_add_u32 s62, s15, 262144
    s_add_u32 s69, s69, s62
    s_add_u32 s26, s3, s60
    s_and_b32 s26, s26, 3
    s_lshl_b32 s26, s26, 14
    s_add_u32 m0, s100, 61440
    s_add_u32 s91, s11, 57344
    buffer_load_dwordx4 v240, s[48:51], s91 offen offset:0 lds
    s_add_u32 s61, s26, s62
    s_lshr_b32 s26, s3, 1
    s_lshl_b32 s26, s26, 14
    s_and_b32 s89, s3, 1
    s_mul_i32 s89, s89, 3584
    s_add_u32 s26, s26, s89
    buffer_load_dwordx4 v241, s[48:51], s91 offen offset:1024 lds
    s_add_u32 s26, s26, s15
    s_add_u32 s63, s26, 524288
    s_add_u32 s67, s15, 557056
    s_lshl3_add_u32 s26, s77, s3
    s_lshl_b32 s26, s26, 11
    s_add_u32 s64, s26, s67
    buffer_load_dwordx4 v242, s[48:51], s91 offen offset:2048 lds
    s_mul_i32 s65, s3, 401408
    s_lshl_b32 s26, s79, 7
    s_add_u32 s65, s65, s26
    s_mul_i32 s66, s3, 10240
    s_add_u32 s66, s66, 114688
L_pad3:
    s_cbranch_execz L_body
    s_mul_i32 s68, s57, 114688
    s_add_u32 m0, s100, 28672
    s_nop 0
    buffer_load_dwordx4 v240, s[52:55], s9 offen offset:0 lds
    s_add_u32 s68, s68, s26
    s_mul_i32 s70, s59, 0
    s_add_u32 s70, s70, s79
    s_sub_u32 s26, s70, 7
    s_cmp_ge_u32 s70, 7
    s_cselect_b32 s70, s26, s70
    s_cmp_lg_u32 s3, 0
    s_cbranch_scc1 L_w0_13
    s_and_b32 s36, s79, 3
    s_lshl_b32 s36, s36, 10
    s_add_u32 s36, s36, s98
    s_atomic_umax s88, s[24:25], s36 offset:16384 glc
L_w0_13:
    s_waitcnt vmcnt(8)
    s_barrier
    s_nop 0
    buffer_load_dwordx4 v241, s[52:55], s9 offen offset:1024 lds
    ds_read_b64_tr_b16 a[56:57], v7 offset:28672
    buffer_load_dwordx4 v242, s[52:55], s9 offen offset:2048 lds
    ds_read_b64_tr_b16 a[58:59], v7 offset:30720
    ds_read_b64_tr_b16 a[60:61], v7 offset:32768
    ds_read_b64_tr_b16 a[62:63], v7 offset:34816
    buffer_load_dwordx4 v245, s[52:55], s9 offen offset:3072 lds
    ds_read_b64_tr_b16 a[64:65], v7 offset:36864
    ds_read_b64_tr_b16 a[66:67], v7 offset:38912
    s_add_u32 m0, s100, 32768
    s_add_u32 s91, s9, 57344
    buffer_load_dwordx4 v240, s[52:55], s91 offen offset:0 lds
    ds_read_b64_tr_b16 a[68:69], v7 offset:40960
    ds_read_b64_tr_b16 a[70:71], v7 offset:43008
    ds_read_b64_tr_b16 a[72:73], v7 offset:45056
    buffer_load_dwordx4 v241, s[52:55], s91 offen offset:1024 lds
    ds_read_b64_tr_b16 a[74:75], v7 offset:47104
    ds_read_b64_tr_b16 a[76:77], v7 offset:49152
    buffer_load_dwordx4 v242, s[52:55], s91 offen offset:2048 lds
    ds_read_b64_tr_b16 a[78:79], v7 offset:51200
    ds_read_b64_tr_b16 a[80:81], v7 offset:53248
    ds_read_b64_tr_b16 a[82:83], v7 offset:55296
    s_waitcnt lgkmcnt(0)
    v_lshlrev_b32 v80, 16, v112
    v_and_b32 v81, 0xffff0000, v112
    v_lshlrev_b32 v82, 16, v113
    v_and_b32 v83, 0xffff0000, v113
    v_lshlrev_b32 v84, 16, v114
    v_and_b32 v85, 0xffff0000, v114
    v_lshlrev_b32 v86, 16, v115
    v_and_b32 v87, 0xffff0000, v115
    v_lshlrev_b32 v88, 16, v116
    v_and_b32 v89, 0xffff0000, v116
    v_lshlrev_b32 v90, 16, v117
    v_and_b32 v91, 0xffff0000, v117
    v_lshlrev_b32 v92, 16, v118
    v_and_b32 v93, 0xffff0000, v118
    v_lshlrev_b32 v94, 16, v119
    v_and_b32 v95, 0xffff0000, v119
    s_cmp_lg_u32 s3, 0
    s_cbranch_scc1 L_w0_16
    s_mov_b32 s89, 0
L_poll_14:
    s_waitcnt lgkmcnt(0)
    s_cmp_ge_u32 s88, 16
    s_cbranch_scc1 L_done_15
    s_atomic_umax s88, s[24:25], s36 offset:16384 glc
    s_add_u32 s89, s89, 1
    s_cmp_lt_u32 s89, 131072
    s_cbranch_scc1 L_poll_14
L_done_15:
L_w0_16:
    s_barrier
    s_add_u32 m0, s13, 0
    s_add_u32 s62, s27, 0
    buffer_load_dwordx4 v1, s[40:43], s62 offen offset:0 sc1 lds
    buffer_load_dwordx4 v1, s[40:43], s62 offen offset:1024 sc1 lds
    buffer_load_dwordx4 v1, s[40:43], s62 offen offset:2048 sc1 lds
    buffer_load_dwordx4 v1, s[40:43], s62 offen offset:3072 sc1 lds
    s_add_u32 m0, s13, 8192
    s_add_u32 s62, s27, 16384
    buffer_load_dwordx4 v1, s[40:43], s62 offen offset:0 sc1 lds
    buffer_load_dwordx4 v1, s[40:43], s62 offen offset:1024 sc1 lds
    buffer_load_dwordx4 v1, s[40:43], s62 offen offset:2048 sc1 lds
    buffer_load_dwordx4 v1, s[40:43], s62 offen offset:3072 sc1 lds
    v_mfma_f32_16x16x32_bf16 v[144:147], v[128:131], a[0:3], 0
    s_add_u32 m0, s13, 16384
    s_add_u32 s62, s12, 0
    s_nop 0
    buffer_load_dwordx4 v1, s[40:43], s62 offen offset:0 sc1 lds
    v_mfma_f32_16x16x32_bf16 v[144:147], v[128:131], a[4:7], v[144:147]
    v_mfma_f32_16x16x32_bf16 v[144:147], v[128:131], a[8:11], v[144:147]
    v_mfma_f32_16x16x32_bf16 v[144:147], v[128:131], a[12:15], v[144:147]
    v_mfma_f32_16x16x32_bf16 v[144:147], v[128:131], a[16:19], v[144:147]
    v_mfma_f32_16x16x32_bf16 v[144:147], v[128:131], a[20:23], v[144:147]
    v_mfma_f32_16x16x32_bf16 v[144:147], v[128:131], a[24:27], v[144:147]
    v_mfma_f32_16x16x32_bf16 v[144:147], v[128:131], a[28:31], v[144:147]
    buffer_load_dwordx4 v1, s[40:43], s62 offen offset:1024 sc1 lds
    v_mfma_f32_16x16x32_bf16 v[144:147], v[128:131], a[32:35], v[144:147]
    v_mfma_f32_16x16x32_bf16 v[144:147], v[128:131], a[36:39], v[144:147]
    v_mfma_f32_16x16x32_bf16 v[144:147], v[128:131], a[40:43], v[144:147]
    v_mfma_f32_16x16x32_bf16 v[144:147], v[128:131], a[44:47], v[144:147]
    v_mfma_f32_16x16x32_bf16 v[144:147], v[128:131], a[48:51], v[144:147]
    v_mfma_f32_16x16x32_bf16 v[144:147], v[128:131], a[52:55], v[144:147]
    s_waitcnt vmcnt(8)
    s_barrier
    ds_read_b128 v[16:19], v2 offset:0
    ds_read_b128 v[20:23], v2 offset:4096
    ds_read_b128 v[24:27], v2 offset:1024
    ds_read_b128 v[28:31], v2 offset:5120
    s_waitcnt lgkmcnt(3)
    v_mfma_f32_32x32x16_bf16 v[80:95], a[112:115], v[16:19], v[80:95]
    buffer_load_dwordx4 v1, s[40:43], s62 offen offset:2048 sc1 lds
    s_lshl_b32 s27, s75, 1
    s_waitcnt vmcnt(7)
    s_barrier
    ds_read_b128 v[32:35], v2 offset:2048
    s_waitcnt lgkmcnt(3)
    v_mfma_f32_32x32x16_bf16 v[80:95], a[128:131], v[20:23], v[80:95]
    buffer_load_dwordx4 v1, s[40:43], s62 offen offset:3072 sc1 lds
    ds_read_b64_tr_b16 a[84:85], v7 offset:0
    ds_read_b64_tr_b16 a[86:87], v7 offset:2048
    ds_read_b128 v[36:39], v2 offset:6144
    s_mul_i32 s26, s27, 37
    s_waitcnt lgkmcnt(5)
    v_mfma_f32_32x32x16_bf16 v[80:95], a[116:119], v[24:27], v[80:95]
    s_add_u32 m0, s13, 24576
    s_add_u32 s62, s12, 16384
    buffer_load_dwordx4 v1, s[40:43], s62 offen offset:0 sc1 lds
    ds_read_b64_tr_b16 a[88:89], v7 offset:4096
    ds_read_b128 v[40:43], v2 offset:3072
    s_waitcnt lgkmcnt(6)
    v_mfma_f32_32x32x16_bf16 v[80:95], a[132:135], v[28:31], v[80:95]
    buffer_load_dwordx4 v1, s[40:43], s62 offen offset:1024 sc1 lds
    ds_read_b64_tr_b16 a[90:91], v7 offset:6144
    ds_read_b64_tr_b16 a[92:93], v7 offset:8192
    ds_read_b128 v[44:47], v2 offset:7168
    s_lshr_b32 s26, s26, 8
    s_waitcnt lgkmcnt(8)
    v_mfma_f32_32x32x16_bf16 v[80:95], a[120:123], v[32:35], v[80:95]
    buffer_load_dwordx4 v1, s[40:43], s62 offen offset:2048 sc1 lds
    ds_read_b64_tr_b16 a[94:95], v7 offset:10240
    s_waitcnt vmcnt(9)
    s_barrier
    ds_read_b128 v[48:51], v2 offset:8192
    s_waitcnt lgkmcnt(7)
    v_mfma_f32_32x32x16_bf16 v[80:95], a[136:139], v[36:39], v[80:95]
    buffer_load_dwordx4 v1, s[40:43], s62 offen offset:3072 sc1 lds
    ds_read_b64_tr_b16 a[96:97], v7 offset:12288
    ds_read_b64_tr_b16 a[98:99], v7 offset:14336
    ds_read_b128 v[52:55], v2 offset:12288
    s_mul_i32 s26, s26, 9
    s_waitcnt lgkmcnt(8)
    v_mfma_f32_32x32x16_bf16 v[80:95], a[124:127], v[40:43], v[80:95]
    ds_read_b64_tr_b16 a[100:101], v7 offset:16384
    ds_read_b128 v[56:59], v2 offset:9216
    s_add_u32 s90, s26, s27
    s_lshl_b32 s90, s90, 10
    s_add_u32 s27, s27, 1
    s_waitcnt lgkmcnt(7)
    v_mfma_f32_32x32x16_bf16 v[80:95], a[140:143], v[44:47], v[80:95]
    ds_read_b64_tr_b16 a[102:103], v7 offset:18432
    ds_read_b64_tr_b16 a[104:105], v7 offset:20480
    ds_read_b128 v[60:63], v2 offset:13312
    s_mul_i32 s26, s27, 37
    s_lshr_b32 s26, s26, 8
    s_waitcnt lgkmcnt(8)
    v_mfma_f32_32x32x16_bf16 v[80:95], a[144:147], v[48:51], v[80:95]
    ds_read_b64_tr_b16 a[106:107], v7 offset:22528
    s_mul_i32 s26, s26, 9
    s_waitcnt vmcnt(8)
    s_barrier
    ds_read_b128 v[64:67], v2 offset:10240
    s_waitcnt lgkmcnt(7)
    v_mfma_f32_32x32x16_bf16 v[80:95], a[160:163], v[52:55], v[80:95]
    ds_read_b64_tr_b16 a[108:109], v7 offset:24576
    ds_read_b64_tr_b16 a[110:111], v7 offset:26624
    ds_read_b128 v[68:71], v2 offset:14336
    s_add_u32 s17, s26, s27
    s_lshl_b32 s17, s17, 10
    s_waitcnt lgkmcnt(8)
    v_mfma_f32_32x32x16_bf16 v[80:95], a[148:151], v[56:59], v[80:95]
    ds_read_b128 v[72:75], v2 offset:11264
    s_and_b32 s26, s73, 3
    s_lshl_b32 s26, s26, 16
    s_add_u32 s26, s26, s16
    s_add_u32 s26, s26, 262144
    s_waitcnt lgkmcnt(6)
    v_mfma_f32_32x32x16_bf16 v[80:95], a[164:167], v[60:63], v[80:95]
    ds_read_b128 v[76:79], v2 offset:15360
    s_add_u32 s90, s90, s26
    s_add_u32 s17, s17, s26
    s_and_b32 s26, s73, 2
    s_lshl4_add_u32 s26, s26, 0
    s_waitcnt lgkmcnt(5)
    v_mfma_f32_32x32x16_bf16 v[80:95], a[152:155], v[64:67], v[80:95]
    s_and_b32 s27, s73, 1
    s_waitcnt vmcnt(6)
    s_waitcnt lgkmcnt(3)
    s_barrier
    ds_read_b128 v[16:19], v2 offset:16384
    s_waitcnt lgkmcnt(3)
    v_mfma_f32_32x32x16_bf16 v[80:95], a[168:171], v[68:71], v[80:95]
    ds_read_b128 v[20:23], v2 offset:20480
    s_mul_i32 s27, s27, 7
    s_add_u32 s26, s26, s27
    s_lshl1_add_u32 s26, s26, s75
    s_lshl_b32 s26, s26, 8
    s_waitcnt lgkmcnt(3)
    v_mfma_f32_32x32x16_bf16 v[80:95], a[156:159], v[72:75], v[80:95]
    s_add_u32 m0, s100, 57344
    s_nop 0
    buffer_load_dwordx4 v240, s[52:55], s10 offen offset:0 lds
    ds_read_b128 v[24:27], v2 offset:17408
    s_add_u32 s26, s26, s16
    s_add_u32 s101, s26, 524288
    s_waitcnt lgkmcnt(3)
    v_mfma_f32_32x32x16_bf16 v[80:95], a[172:175], v[76:79], v[80:95]
    ds_read_b128 v[28:31], v2 offset:21504
    v_mov_b32 v96, 0
    v_mov_b32 v97, 0
    v_lshlrev_b32 v250, 2, v0
    v_add_u32 v248, 57344, v1
    s_waitcnt lgkmcnt(3)
    v_mfma_f32_32x32x16_bf16 v[80:95], a[176:179], v[16:19], v[80:95]
    buffer_load_dwordx4 v241, s[52:55], s10 offen offset:1024 lds
    v_add_u32 v249, 159744, v1
    s_waitcnt vmcnt(6)
    s_barrier
    ds_read_b128 v[32:35], v2 offset:18432
    s_waitcnt lgkmcnt(3)
    v_mfma_f32_32x32x16_bf16 v[80:95], a[192:195], v[20:23], v[80:95]
    ds_read_b128 v[36:39], v2 offset:22528
    v_lshrrev_b32 v4, 3, v0
    v_and_b32 v3, 6, v4
    v_xor_b32 v3, v3, v0
    v_and_b32 v3, 7, v3
    s_waitcnt lgkmcnt(3)
    v_mfma_f32_32x32x16_bf16 v[80:95], a[180:183], v[24:27], v[80:95]
    buffer_load_dwordx4 v242, s[52:55], s10 offen offset:2048 lds
    ds_read_b128 v[40:43], v2 offset:19456
    v_lshlrev_b32 v3, 4, v3
    v_mul_u32_u24 v4, 896, v4
    v_add_u32 v251, v4, v3
    s_waitcnt lgkmcnt(3)
    v_mfma_f32_32x32x16_bf16 v[80:95], a[196:199], v[28:31], v[80:95]
    ds_read_b128 v[44:47], v2 offset:23552
    v_add_u32 v252, 6144, v251
    v_bfe_u32 v4, v0, 3, 2
    v_xor_b32 v4, s3, v4
    v_lshlrev_b32 v4, 5, v4
    s_waitcnt lgkmcnt(3)
    v_mfma_f32_32x32x16_bf16 v[80:95], a[184:187], v[32:35], v[80:95]
    buffer_load_dwordx4 v245, s[52:55], s10 offen offset:3072 lds
    v_lshrrev_b32 v3, 2, v0
    s_waitcnt vmcnt(6)
    s_barrier
    ds_read_b128 v[48:51], v2 offset:24576
    s_waitcnt lgkmcnt(3)
    v_mfma_f32_32x32x16_bf16 v[80:95], a[200:203], v[36:39], v[80:95]
    ds_read_b128 v[52:55], v2 offset:28672
    v_lshl_add_u32 v4, v3, 7, v4
    v_and_b32 v3, 3, v0
    v_lshl_add_u32 v4, v3, 3, v4
    v_add_u32 v253, s66, v4
    s_waitcnt lgkmcnt(3)
    v_mfma_f32_32x32x16_bf16 v[80:95], a[188:191], v[40:43], v[80:95]
    s_add_u32 m0, s100, 61440
    s_add_u32 s91, s10, 57344
    buffer_load_dwordx4 v240, s[52:55], s91 offen offset:0 lds
    ds_read_b128 v[56:59], v2 offset:25600
    v_add_u32 v243, s100, v4
    s_waitcnt lgkmcnt(3)
    v_mfma_f32_32x32x16_bf16 v[80:95], a[204:207], v[44:47], v[80:95]
    ds_read_b128 v[60:63], v2 offset:29696
    v_xor_b32 v11, 32, v253
    v_xor_b32 v244, 32, v243
    v_xor_b32 v15, 64, v253
    v_xor_b32 v246, 64, v243
    s_waitcnt lgkmcnt(3)
    v_mfma_f32_32x32x16_bf16 v[80:95], a[208:211], v[48:51], v[80:95]
    buffer_load_dwordx4 v241, s[52:55], s91 offen offset:1024 lds
    v_xor_b32 v14, 96, v253
    s_waitcnt vmcnt(6)
    s_barrier
    ds_read_b128 v[64:67], v2 offset:26624
    s_waitcnt lgkmcnt(3)
    v_mfma_f32_32x32x16_bf16 v[80:95], a[224:227], v[52:55], v[80:95]
    ds_read_b128 v[68:71], v2 offset:30720
    v_xor_b32 v247, 96, v243
    s_waitcnt lgkmcnt(3)
    v_mfma_f32_32x32x16_bf16 v[80:95], a[212:215], v[56:59], v[80:95]
    buffer_load_dwordx4 v242, s[52:55], s91 offen offset:2048 lds
    ds_read_b128 v[72:75], v2 offset:27648
    s_waitcnt lgkmcnt(3)
    v_mfma_f32_32x32x16_bf16 v[80:95], a[228:231], v[60:63], v[80:95]
    ds_read_b128 v[76:79], v2 offset:31744
    s_waitcnt lgkmcnt(3)
    v_mfma_f32_32x32x16_bf16 v[80:95], a[216:219], v[64:67], v[80:95]
    s_waitcnt lgkmcnt(2)
    v_mfma_f32_32x32x16_bf16 v[80:95], a[232:235], v[68:71], v[80:95]
    s_waitcnt lgkmcnt(1)
    v_mfma_f32_32x32x16_bf16 v[80:95], a[220:223], v[72:75], v[80:95]
    s_waitcnt lgkmcnt(0)
    v_mfma_f32_32x32x16_bf16 v[80:95], a[236:239], v[76:79], v[80:95]
    s_nop 11
    s_nop 0
    v_cvt_pk_bf16_f32 v16, v80, v81
    v_cvt_pk_bf16_f32 v17, v82, v83
    v_cvt_pk_bf16_f32 v18, v84, v85
    v_cvt_pk_bf16_f32 v19, v86, v87
    buffer_store_dwordx4 v[16:19], v1, s[40:43], s90 offen sc1
    v_cvt_pk_bf16_f32 v20, v88, v89
    v_cvt_pk_bf16_f32 v21, v90, v91
    v_cvt_pk_bf16_f32 v22, v92, v93
    v_cvt_pk_bf16_f32 v23, v94, v95
    buffer_store_dwordx4 v[20:23], v1, s[40:43], s17 offen sc1
    v_dot2c_f32_bf16 v96, s83, v16
    v_dot2c_f32_bf16 v97, v16, v16
    v_dot2c_f32_bf16 v96, s83, v17
    v_dot2c_f32_bf16 v97, v17, v17
    v_dot2c_f32_bf16 v96, s83, v18
    v_dot2c_f32_bf16 v97, v18, v18
    v_dot2c_f32_bf16 v96, s83, v19
    v_dot2c_f32_bf16 v97, v19, v19
    v_dot2c_f32_bf16 v96, s83, v20
    v_dot2c_f32_bf16 v97, v20, v20
    v_dot2c_f32_bf16 v96, s83, v21
    v_dot2c_f32_bf16 v97, v21, v21
    v_dot2c_f32_bf16 v96, s83, v22
    v_dot2c_f32_bf16 v97, v22, v22
    v_dot2c_f32_bf16 v96, s83, v23
    v_dot2c_f32_bf16 v97, v23, v23
    s_nop 2
    v_permlane32_swap_b32 v96, v97
    v_add_f32 v96, v96, v97
    buffer_store_dword v96, v250, s[40:43], s101 offen sc1
    s_waitcnt vmcnt(3)
    s_barrier
    v_mfma_f32_16x16x32_bf16 v[144:147], v[128:131], a[56:59], v[144:147]
    s_add_u32 m0, s100, 86016
    s_nop 0
    buffer_load_dwordx4 v240, s[52:55], s11 offen offset:0 lds
    ds_read_b64_tr_b16 a[112:113], v6 offset:0
    ds_read_b64_tr_b16 a[114:115], v6 offset:2048
    s_add_u32 s26, s65, 401408
    v_mfma_f32_16x16x32_bf16 v[144:147], v[128:131], a[60:63], v[144:147]
    ds_read_b64_tr_b16 a[116:117], v6 offset:4096
    ds_read_b64_tr_b16 a[118:119], v6 offset:6144
    ds_read_b64_tr_b16 a[120:121], v6 offset:8192
    s_mul_i32 s44, s70, 57344
    s_add_u32 s44, s44, s65
    s_nop 0
    v_mfma_f32_16x16x32_bf16 v[144:147], v[128:131], a[64:67], v[144:147]
    buffer_load_dwordx4 v241, s[52:55], s11 offen offset:1024 lds
    ds_read_b64_tr_b16 a[122:123], v6 offset:10240
    ds_read_b64_tr_b16 a[124:125], v6 offset:12288
    ds_read_b64_tr_b16 a[126:127], v6 offset:14336
    s_add_u32 s45, s44, 57344
    v_mfma_f32_16x16x32_bf16 v[144:147], v[128:131], a[68:71], v[144:147]
    ds_read_b64_tr_b16 a[128:129], v6 offset:16384
    ds_read_b64_tr_b16 a[130:131], v6 offset:18432
    ds_read_b64_tr_b16 a[132:133], v6 offset:20480
    s_cmp_eq_u32 s45, s26
    s_cselect_b32 s45, s65, s45
    v_mfma_f32_16x16x32_bf16 v[144:147], v[128:131], a[72:75], v[144:147]
    buffer_load_dwordx4 v242, s[52:55], s11 offen offset:2048 lds
    ds_read_b64_tr_b16 a[134:135], v6 offset:22528
    ds_read_b64_tr_b16 a[136:137], v6 offset:24576
    ds_read_b64_tr_b16 a[138:139], v6 offset:26624
    s_add_u32 s46, s45, 57344
    v_mfma_f32_16x16x32_bf16 v[144:147], v[128:131], a[76:79], v[144:147]
    ds_read_b64_tr_b16 a[140:141], v6 offset:28672
    ds_read_b64_tr_b16 a[142:143], v6 offset:30720
    ds_read_b64_tr_b16 a[144:145], v6 offset:32768
    s_cmp_eq_u32 s46, s26
    s_cselect_b32 s46, s65, s46
    v_mfma_f32_16x16x32_bf16 v[144:147], v[128:131], a[80:83], v[144:147]
    buffer_load_dwordx4 v245, s[52:55], s11 offen offset:3072 lds
    ds_read_b64_tr_b16 a[146:147], v6 offset:34816
    ds_read_b64_tr_b16 a[148:149], v6 offset:36864
    ds_read_b64_tr_b16 a[150:151], v6 offset:38912
    s_add_u32 s47, s46, 57344
    v_mfma_f32_16x16x32_bf16 v[144:147], v[128:131], a[84:87], v[144:147]
    ds_read_b64_tr_b16 a[152:153], v6 offset:40960
    ds_read_b64_tr_b16 a[154:155], v6 offset:43008
    ds_read_b64_tr_b16 a[156:157], v6 offset:45056
    s_cmp_eq_u32 s47, s26
    s_cselect_b32 s47, s65, s47
    v_mfma_f32_16x16x32_bf16 v[144:147], v[128:131], a[88:91], v[144:147]
    s_add_u32 m0, s100, 90112
    s_add_u32 s91, s11, 57344
    buffer_load_dwordx4 v240, s[52:55], s91 offen offset:0 lds
    ds_read_b64_tr_b16 a[158:159], v6 offset:47104
    ds_read_b64_tr_b16 a[160:161], v6 offset:49152
    ds_read_b64_tr_b16 a[162:163], v6 offset:51200
    v_mfma_f32_16x16x32_bf16 v[144:147], v[128:131], a[92:95], v[144:147]
    ds_read_b64_tr_b16 a[164:165], v6 offset:53248
    ds_read_b64_tr_b16 a[166:167], v6 offset:55296
    ds_read_b64_tr_b16 a[168:169], v7 offset:0
    s_add_u32 s48, s47, 57344
    s_cmp_eq_u32 s48, s26
    s_cselect_b32 s48, s65, s48
    v_mfma_f32_16x16x32_bf16 v[144:147], v[128:131], a[96:99], v[144:147]
    buffer_load_dwordx4 v241, s[52:55], s91 offen offset:1024 lds
    ds_read_b64_tr_b16 a[170:171], v7 offset:2048
    ds_read_b64_tr_b16 a[172:173], v7 offset:4096
    ds_read_b64_tr_b16 a[174:175], v7 offset:6144
    s_add_u32 s49, s48, 57344
    v_mfma_f32_16x16x32_bf16 v[144:147], v[128:131], a[100:103], v[144:147]
    ds_read_b64_tr_b16 a[176:177], v7 offset:8192
    ds_read_b64_tr_b16 a[178:179], v7 offset:10240
    ds_read_b64_tr_b16 a[180:181], v7 offset:12288
    s_cmp_eq_u32 s49, s26
    s_cselect_b32 s49, s65, s49
    v_mfma_f32_16x16x32_bf16 v[144:147], v[128:131], a[104:107], v[144:147]
    buffer_load_dwordx4 v242, s[52:55], s91 offen offset:2048 lds
    ds_read_b64_tr_b16 a[182:183], v7 offset:14336
    ds_read_b64_tr_b16 a[184:185], v7 offset:16384
    ds_read_b64_tr_b16 a[186:187], v7 offset:18432
    s_add_u32 s50, s49, 57344
    v_mfma_f32_16x16x32_bf16 v[144:147], v[128:131], a[108:111], v[144:147]
    ds_read_b64_tr_b16 a[188:189], v7 offset:20480
    ds_read_b64_tr_b16 a[190:191], v7 offset:22528
    ds_read_b64_tr_b16 a[192:193], v7 offset:24576
    ds_read_b64_tr_b16 a[194:195], v7 offset:26624
    s_cmp_eq_u32 s50, s26
    s_cselect_b32 s50, s65, s50
    s_waitcnt vmcnt(7)
    s_waitcnt lgkmcnt(0)
    s_barrier
    s_cmp_lg_u32 s3, 0
    s_cbranch_scc1 L_w0_17
    s_waitcnt lgkmcnt(0)
    s_mov_b32 s88, 0
    s_mov_b32 s37, 0
    s_atomic_add s99, s[24:25], s98 offset:20480
    s_atomic_add s99, s[24:25], s98 offset:21504
    s_atomic_add s99, s[24:25], s98 offset:22528
    s_atomic_add s99, s[24:25], s98 offset:23552
L_w0_17:
    v_cvt_pk_bf16_f32 v132, v144, v144
    v_and_b32 v133, 0xffff0000, v132
    v_sub_f32 v133, v144, v133
    v_cvt_pk_bf16_f32 v133, v133, 0
    v_and_b32 v132, v132, v13
    v_and_b32 v133, v133, v13
    v_accvgpr_write_b32 a240, v132
    v_accvgpr_write_b32 a241, v133
    v_accvgpr_write_b32 a242, 0
    v_accvgpr_write_b32 a243, 0
    v_mfma_f32_16x16x32_bf16 v[144:147], v[128:131], a[112:115], 0
    s_add_u32 m0, s66, 0
    s_add_u32 s13, s44, 0
    buffer_load_dwordx4 v251, s[32:35], s13 offen lds
    s_add_u32 s26, s72, 28672
    s_mul_i32 s4, s70, 4096
    v_mfma_f32_16x16x32_bf16 v[144:147], v[128:131], a[116:119], v[144:147]
    buffer_load_dwordx4 v252, s[32:35], s13 offen offset:1024 lds
    s_add_u32 s4, s4, s72
    s_add_u32 s5, s4, 4096
    s_cmp_eq_u32 s5, s26
    s_cselect_b32 s5, s72, s5
    v_mfma_f32_16x16x32_bf16 v[144:147], v[128:131], a[120:123], v[144:147]
    s_add_u32 s6, s5, 4096
    s_cmp_eq_u32 s6, s26
    s_cselect_b32 s6, s72, s6
    s_add_u32 s7, s6, 4096
    s_cmp_eq_u32 s7, s26
    s_cselect_b32 s7, s72, s7
    v_mfma_f32_16x16x32_bf16 v[144:147], v[128:131], a[124:127], v[144:147]
    s_add_u32 m0, s66, 2048
    s_add_u32 s13, s44, 14336
    buffer_load_dwordx4 v251, s[32:35], s13 offen lds
    s_add_u32 s8, s7, 4096
    s_cmp_eq_u32 s8, s26
    s_cselect_b32 s8, s72, s8
    v_mfma_f32_16x16x32_bf16 v[144:147], v[128:131], a[128:131], v[144:147]
    s_cmp_lg_u32 s3, 0
    s_cbranch_scc1 L_w0_18
    s_and_b32 s36, s79, 3
    s_lshl_b32 s36, s36, 10
    s_add_u32 s36, s36, s87
    s_atomic_umax s88, s[24:25], s36 offset:20480 glc
L_w0_18:
    v_mfma_f32_16x16x32_bf16 v[144:147], v[128:131], a[132:135], v[144:147]
    buffer_load_dwordx4 v252, s[32:35], s13 offen offset:1024 lds
    s_add_u32 s9, s8, 4096
    s_cmp_eq_u32 s9, s26
    s_cselect_b32 s9, s72, s9
    s_add_u32 s10, s9, 4096
    v_mfma_f32_16x16x32_bf16 v[144:147], v[128:131], a[136:139], v[144:147]
    s_add_u32 m0, s66, 4096
    s_add_u32 s13, s44, 28672
    buffer_load_dwordx4 v251, s[32:35], s13 offen lds
    s_cmp_eq_u32 s10, s26
    s_cselect_b32 s10, s72, s10
    v_mfma_f32_16x16x32_bf16 v[144:147], v[128:131], a[140:143], v[144:147]
    s_and_b32 s26, s4, 0xffffe000
    s_add_u32 s26, s26, s67
    s_add_u32 s4, s4, s26
    s_and_b32 s26, s5, 0xffffe000
    s_add_u32 s26, s26, s67
    v_mfma_f32_16x16x32_bf16 v[144:147], v[128:131], a[144:147], v[144:147]
    buffer_load_dwordx4 v252, s[32:35], s13 offen offset:1024 lds
    s_add_u32 s5, s5, s26
    s_and_b32 s26, s6, 0xffffe000
    s_add_u32 s26, s26, s67
    s_add_u32 s6, s6, s26
    v_mfma_f32_16x16x32_bf16 v[144:147], v[128:131], a[148:151], v[144:147]
    s_and_b32 s26, s7, 0xffffe000
    s_add_u32 s26, s26, s67
    s_add_u32 s7, s7, s26
    s_and_b32 s26, s8, 0xffffe000
    s_add_u32 s26, s26, s67
    v_mfma_f32_16x16x32_bf16 v[144:147], v[128:131], a[152:155], v[144:147]
    s_add_u32 m0, s66, 6144
    s_add_u32 s13, s44, 43008
    buffer_load_dwordx4 v251, s[32:35], s13 offen lds
    s_add_u32 s8, s8, s26
    s_and_b32 s26, s9, 0xffffe000
    v_mfma_f32_16x16x32_bf16 v[144:147], v[128:131], a[156:159], v[144:147]
    buffer_load_dwordx4 v252, s[32:35], s13 offen offset:1024 lds
    s_add_u32 s26, s26, s67
    s_add_u32 s9, s9, s26
    s_and_b32 s26, s10, 0xffffe000
    s_add_u32 s26, s26, s67
    v_mfma_f32_16x16x32_bf16 v[144:147], v[128:131], a[160:163], v[144:147]
    s_add_u32 s10, s10, s26
    v_mfma_f32_16x16x32_bf16 v[144:147], v[128:131], a[164:167], v[144:147]
    s_add_u32 m0, s66, 8192
    s_add_u32 s13, s45, 0
    buffer_load_dwordx4 v251, s[32:35], s13 offen lds
    v_mfma_f32_16x16x32_bf16 v[144:147], v[128:131], a[168:171], v[144:147]
    v_mfma_f32_16x16x32_bf16 v[144:147], v[128:131], a[172:175], v[144:147]
    buffer_load_dwordx4 v252, s[32:35], s13 offen offset:1024 lds
    s_cmp_eq_u32 s3, 0
    s_cbranch_scc1 L_hopped
    s_mov_b32 s82, 2
    s_mov_b64 exec, 0
    s_cmp_eq_u32 s3, 1
    s_cbranch_scc1 L_pad5
    s_cmp_eq_u32 s3, 2
    s_cbranch_scc1 L_pad6
    s_branch L_hopret
L_hopret:
    s_cmp_eq_u32 s82, 2
    s_cbranch_scc0 L_end
    s_mov_b32 s82, 0
    s_mov_b64 exec, -1
L_hopped:
    s_cmp_lg_u32 s3, 0
    s_cbranch_scc1 L_w0_21
    s_mov_b32 s89, 0
L_poll_19:
    s_waitcnt lgkmcnt(0)
    s_cmp_ge_u32 s88, 14
    s_cbranch_scc1 L_done_20
    s_atomic_umax s88, s[24:25], s36 offset:20480 glc
    s_add_u32 s89, s89, 1
    s_cmp_lt_u32 s89, 131072
    s_cbranch_scc1 L_poll_19
L_done_20:
L_w0_21:
    s_barrier
    s_add_u32 m0, s100, 0
    s_add_u32 s12, s61, 0
    buffer_load_dwordx4 v1, s[40:43], s12 offen offset:0 sc1 lds
    buffer_load_dwordx4 v1, s[40:43], s12 offen offset:1024 sc1 lds
    buffer_load_dwordx4 v1, s[40:43], s12 offen offset:2048 sc1 lds
    buffer_load_dwordx4 v1, s[40:43], s12 offen offset:3072 sc1 lds
    v_mfma_f32_16x16x32_bf16 v[144:147], v[128:131], a[176:179], v[144:147]
    s_add_u32 m0, s100, 4096
    s_add_u32 s12, s61, 4096
    buffer_load_dwordx4 v1, s[40:43], s12 offen offset:0 sc1 lds
    buffer_load_dwordx4 v1, s[40:43], s12 offen offset:1024 sc1 lds
    v_mfma_f32_16x16x32_bf16 v[144:147], v[128:131], a[180:183], v[144:147]
    buffer_load_dwordx4 v1, s[40:43], s12 offen offset:2048 sc1 lds
    v_mfma_f32_16x16x32_bf16 v[144:147], v[128:131], a[184:187], v[144:147]
    s_add_u32 m0, s100, 28672
    s_add_u32 s12, s61, 65536
    buffer_load_dwordx4 v1, s[40:43], s12 offen offset:0 sc1 lds
    buffer_load_dwordx4 v1, s[40:43], s12 offen offset:1024 sc1 lds
    v_mfma_f32_16x16x32_bf16 v[144:147], v[128:131], a[188:191], v[144:147]
    buffer_load_dwordx4 v1, s[40:43], s12 offen offset:2048 sc1 lds
    v_mfma_f32_16x16x32_bf16 v[144:147], v[128:131], a[192:195], v[144:147]
    buffer_load_dwordx4 v1, s[40:43], s12 offen offset:3072 sc1 lds
    s_waitcnt vmcnt(9)
    s_barrier
    ds_read_b128 v[80:83], v1 offset:0
    ds_read_b128 v[84:87], v1 offset:7168
    ds_read_b128 v[88:91], v1 offset:14336
    ds_read_b128 v[92:95], v1 offset:1024
    s_waitcnt lgkmcnt(3)
    v_mfma_f32_32x32x16_bf16 v[16:31], a[0:3], v[80:83], 0
    buffer_load_dword v48, v250, s[40:43], s63 offen offset:0 sc1
    ds_read_b128 a[248:251], v1 offset:8192
    v_mfma_f32_32x32x16_bf16 v[32:47], a[112:115], v[80:83], 0
    buffer_load_dword v49, v250, s[40:43], s63 offen offset:256 sc1
    ds_read_b64_tr_b16 a[196:197], v7 offset:28672
    ds_read_b64_tr_b16 a[198:199], v7 offset:30720
    s_waitcnt lgkmcnt(5)
    v_mfma_f32_32x32x16_bf16 v[16:31], a[28:31], v[84:87], v[16:31]
    buffer_load_dword v50, v250, s[40:43], s63 offen offset:512 sc1
    ds_read_b128 a[252:255], v1 offset:15360
    v_mfma_f32_32x32x16_bf16 v[32:47], a[140:143], v[84:87], v[32:47]
    buffer_load_dword v51, v250, s[40:43], s63 offen offset:768 sc1
    ds_read_b64_tr_b16 a[200:201], v7 offset:32768
    ds_read_b64_tr_b16 a[202:203], v7 offset:34816
    ds_read_b64_tr_b16 a[204:205], v7 offset:36864
    s_waitcnt lgkmcnt(7)
    v_mfma_f32_32x32x16_bf16 v[16:31], a[56:59], v[88:91], v[16:31]
    buffer_load_dword v52, v250, s[40:43], s63 offen offset:1024 sc1
    s_waitcnt vmcnt(11)
    s_barrier
    s_nop 0
    ds_read_b128 v[80:83], v1 offset:2048
    v_mfma_f32_32x32x16_bf16 v[32:47], a[168:171], v[88:91], v[32:47]
    buffer_load_dword v53, v250, s[40:43], s63 offen offset:1280 sc1
    ds_read_b64_tr_b16 a[206:207], v7 offset:38912
    ds_read_b64_tr_b16 a[208:209], v7 offset:40960
    ds_read_b64_tr_b16 a[210:211], v7 offset:43008
    v_mfma_f32_32x32x16_bf16 v[16:31], a[4:7], v[92:95], v[16:31]
    buffer_load_dword v54, v250, s[40:43], s63 offen offset:1536 sc1
    ds_read_b128 v[84:87], v1 offset:9216
    v_mfma_f32_32x32x16_bf16 v[32:47], a[116:119], v[92:95], v[32:47]
    buffer_load_dword v55, v250, s[40:43], s63 offen offset:1792 sc1
    ds_read_b64_tr_b16 a[212:213], v7 offset:45056
    ds_read_b64_tr_b16 a[214:215], v7 offset:47104
    ds_read_b64_tr_b16 a[216:217], v7 offset:49152
    s_waitcnt lgkmcnt(11)
    s_nop 0
    v_mfma_f32_32x32x16_bf16 v[16:31], a[32:35], a[248:251], v[16:31]
    buffer_load_dword v56, v250, s[40:43], s63 offen offset:2048 sc1
    ds_read_b128 v[88:91], v1 offset:16384
    v_mfma_f32_32x32x16_bf16 v[32:47], a[144:147], a[248:251], v[32:47]
    buffer_load_dword v57, v250, s[40:43], s63 offen offset:2304 sc1
    ds_read_b64_tr_b16 a[218:219], v7 offset:51200
    ds_read_b64_tr_b16 a[220:221], v7 offset:53248
    ds_read_b64_tr_b16 a[222:223], v7 offset:55296
    v_mfma_f32_32x32x16_bf16 v[16:31], a[60:63], a[252:255], v[16:31]
    buffer_load_dword v58, v250, s[40:43], s63 offen offset:2560 sc1
    ds_read_b128 v[92:95], v1 offset:3072
    v_mfma_f32_32x32x16_bf16 v[32:47], a[172:175], a[252:255], v[32:47]
    buffer_load_dword v59, v250, s[40:43], s63 offen offset:2816 sc1
    s_waitcnt lgkmcnt(8)
    s_nop 0
    v_mfma_f32_32x32x16_bf16 v[16:31], a[8:11], v[80:83], v[16:31]
L_pad4:
    s_cbranch_execz L_body
    s_nop 0
    buffer_load_dword v60, v250, s[40:43], s63 offen offset:3072 sc1
    ds_read_b128 a[248:251], v1 offset:10240
    v_mfma_f32_32x32x16_bf16 v[32:47], a[120:123], v[80:83], v[32:47]
    buffer_load_dword v61, v250, s[40:43], s63 offen offset:3328 sc1
    v_mfma_f32_32x32x16_bf16 v[16:31], a[36:39], v[84:87], v[16:31]
    s_add_u32 m0, s100, 32768
    s_add_u32 s12, s61, 69632
    buffer_load_dwordx4 v1, s[40:43], s12 offen offset:0 sc1 lds
    ds_read_b128 a[252:255], v1 offset:17408
    v_mfma_f32_32x32x16_bf16 v[32:47], a[148:151], v[84:87], v[32:47]
    s_waitcnt lgkmcnt(2)
    s_nop 0
    v_mfma_f32_32x32x16_bf16 v[16:31], a[64:67], v[88:91], v[16:31]
    buffer_load_dwordx4 v1, s[40:43], s12 offen offset:1024 sc1 lds
    ds_read_b128 v[80:83], v1 offset:4096
    v_mfma_f32_32x32x16_bf16 v[32:47], a[176:179], v[88:91], v[32:47]
    ds_read_b64_tr_b16 v[112:113], v253 offset:0
    ds_read_b64_tr_b16 v[116:117], v11 offset:0
    v_mfma_f32_32x32x16_bf16 v[16:31], a[12:15], v[92:95], v[16:31]
    buffer_load_dwordx4 v1, s[40:43], s12 offen offset:2048 sc1 lds
    ds_read_b128 v[84:87], v1 offset:11264
    v_mfma_f32_32x32x16_bf16 v[32:47], a[124:127], v[92:95], v[32:47]
    ds_read_b64_tr_b16 v[120:121], v15 offset:0
    ds_read_b64_tr_b16 v[124:125], v14 offset:0
    s_waitcnt lgkmcnt(6)
    s_nop 0
    v_mfma_f32_32x32x16_bf16 v[16:31], a[40:43], a[248:251], v[16:31]
    s_add_u32 m0, s100, 57344
    s_add_u32 s12, s61, 131072
    buffer_load_dwordx4 v1, s[40:43], s12 offen offset:0 sc1 lds
    ds_read_b128 v[88:91], v1 offset:18432
    v_mfma_f32_32x32x16_bf16 v[32:47], a[152:155], a[248:251], v[32:47]
    ds_read_b64_tr_b16 v[114:115], v253 offset:2048
    ds_read_b64_tr_b16 v[118:119], v11 offset:2048
    v_mfma_f32_32x32x16_bf16 v[16:31], a[68:71], a[252:255], v[16:31]
    buffer_load_dwordx4 v1, s[40:43], s12 offen offset:1024 sc1 lds
    s_waitcnt vmcnt(23)
    s_barrier
    ds_read_b128 v[92:95], v1 offset:5120
    v_mfma_f32_32x32x16_bf16 v[32:47], a[180:183], a[252:255], v[32:47]
    ds_read_b64_tr_b16 v[122:123], v15 offset:2048
    ds_read_b64_tr_b16 v[126:127], v14 offset:2048
    v_mfma_f32_16x16x32_bf16 v[144:147], v[128:131], a[196:199], v[144:147]
    v_mfma_f32_16x16x32_bf16 v[144:147], v[128:131], a[200:203], v[144:147]
    v_mfma_f32_16x16x32_bf16 v[144:147], v[128:131], a[204:207], v[144:147]
    v_mfma_f32_16x16x32_bf16 v[144:147], v[128:131], a[208:211], v[144:147]
    v_mfma_f32_16x16x32_bf16 v[144:147], v[128:131], a[212:215], v[144:147]
    v_mfma_f32_16x16x32_bf16 v[144:147], v[128:131], a[216:219], v[144:147]
    v_mfma_f32_16x16x32_bf16 v[144:147], v[128:131], a[220:223], v[144:147]
    s_waitcnt lgkmcnt(8)
    v_mfma_f32_32x32x16_bf16 v[16:31], a[16:19], v[80:83], v[16:31]
    buffer_load_dwordx4 v1, s[40:43], s12 offen offset:2048 sc1 lds
    ds_read_b128 a[248:251], v1 offset:12288
    v_mfma_f32_32x32x16_bf16 v[32:47], a[128:131], v[80:83], v[32:47]
    v_mfma_f32_32x32x16_bf16 v[16:31], a[44:47], v[84:87], v[16:31]
    buffer_load_dwordx4 v1, s[40:43], s12 offen offset:3072 sc1 lds
    ds_read_b128 a[252:255], v1 offset:19456
    v_mfma_f32_32x32x16_bf16 v[32:47], a[156:159], v[84:87], v[32:47]
    s_waitcnt lgkmcnt(4)
    v_mfma_f32_32x32x16_bf16 v[16:31], a[72:75], v[88:91], v[16:31]
    s_add_u32 m0, s100, 61440
    s_add_u32 s12, s61, 135168
    buffer_load_dwordx4 v1, s[40:43], s12 offen offset:0 sc1 lds
    s_barrier
    ds_read_b128 v[80:83], v1 offset:6144
    v_mfma_f32_32x32x16_bf16 v[32:47], a[184:187], v[88:91], v[32:47]
    v_mfma_f32_32x32x16_bf16 v[16:31], a[20:23], v[92:95], v[16:31]
    buffer_load_dwordx4 v1, s[40:43], s12 offen offset:1024 sc1 lds
    ds_read_b128 v[84:87], v1 offset:13312
    s_waitcnt vmcnt(9)
    v_add_f32 v48, v48, v49
    v_add_f32 v48, v48, v50
    v_add_f32 v48, v48, v51
    v_mfma_f32_32x32x16_bf16 v[32:47], a[132:135], v[92:95], v[32:47]
    v_add_f32 v48, v48, v52
    v_add_f32 v48, v48, v53
    v_add_f32 v48, v48, v54
    v_add_f32 v48, v48, v55
    v_add_f32 v48, v48, v56
    s_waitcnt lgkmcnt(2)
    v_mfma_f32_32x32x16_bf16 v[16:31], a[48:51], a[248:251], v[16:31]
    buffer_load_dwordx4 v1, s[40:43], s12 offen offset:2048 sc1 lds
    ds_read_b128 v[88:91], v1 offset:20480
    v_add_f32 v48, v48, v57
    v_add_f32 v48, v48, v58
    v_add_f32 v48, v48, v59
    v_add_f32 v48, v48, v60
    v_mfma_f32_32x32x16_bf16 v[32:47], a[160:163], a[248:251], v[32:47]
    v_add_f32 v48, v48, v61
    v_mul_f32 v49, 0x3b124925, v48
    v_mul_f32 v48, 0x3b124925, v48
    v_add_u32 v250, s71, v249
    s_nop 0
    v_permlane32_swap_b32 v48, v49
    v_mfma_f32_32x32x16_bf16 v[16:31], a[76:79], a[252:255], v[16:31]
    s_add_u32 m0, s100, 86016
    s_add_u32 s12, s61, 196608
    buffer_load_dwordx4 v1, s[40:43], s12 offen offset:0 sc1 lds
    ds_read_b128 v[92:95], v1 offset:21504
    v_fma_f32 v49, -v48, v48, v49
    v_max_f32 v49, 0, v49
    v_mfma_f32_32x32x16_bf16 v[32:47], a[188:191], a[252:255], v[32:47]
    v_add_f32 v55, 0x3727c5ac, v49
    v_rsq_f32 v54, v55
    v_sub_f32 v48, 0, v48
    v_mul_f32 v54, 0xbfb8aa3b, v54
    s_waitcnt lgkmcnt(2)
    v_mfma_f32_32x32x16_bf16 v[16:31], a[24:27], v[80:83], v[16:31]
    buffer_load_dwordx4 v1, s[40:43], s12 offen offset:1024 sc1 lds
    ds_read_b128 a[248:251], v1 offset:22528
    v_cvt_pk_bf16_f32 v53, v48, 0
    v_lshlrev_b32 v50, 16, v53
    v_sub_f32_e64 v50, v48, v50
    v_cvt_pk_bf16_f32 v52, v48, v50
    v_mfma_f32_32x32x16_bf16 v[32:47], a[136:139], v[80:83], v[32:47]
    v_and_b32 v54, 0xffffff7f, v54
    v_and_b32 v55, 0xffffff7f, v55
    ds_write_b128 v250, v[52:55]
    v_mfma_f32_32x32x16_bf16 v[16:31], a[52:55], v[84:87], v[16:31]
    buffer_load_dwordx4 v1, s[40:43], s12 offen offset:2048 sc1 lds
    ds_read_b128 a[252:255], v1 offset:23552
    v_cvt_pk_bf16_f32 v132, v144, v144
    v_and_b32 v133, 0xffff0000, v132
    v_sub_f32 v133, v144, v133
    v_cvt_pk_bf16_f32 v133, v133, 0
    v_mfma_f32_32x32x16_bf16 v[32:47], a[164:167], v[84:87], v[32:47]
    v_and_b32 v132, v132, v13
    v_and_b32 v133, v133, v13
    v_accvgpr_write_b32 a244, v132
    v_accvgpr_write_b32 a245, v133
    v_accvgpr_write_b32 a246, 0
    s_waitcnt lgkmcnt(3)
    v_mfma_f32_32x32x16_bf16 v[16:31], a[80:83], v[88:91], v[16:31]
    buffer_load_dwordx4 v1, s[40:43], s12 offen offset:3072 sc1 lds
    ds_read_b128 v[80:83], v1 offset:24576
    v_accvgpr_write_b32 a247, 0
    v_mfma_f32_32x32x16_bf16 v[32:47], a[192:195], v[88:91], v[32:47]
    v_mfma_f32_32x32x16_bf16 v[16:31], a[84:87], v[92:95], v[16:31]
    s_add_u32 m0, s100, 90112
    s_add_u32 s12, s61, 200704
    buffer_load_dwordx4 v1, s[40:43], s12 offen offset:0 sc1 lds
    ds_read_b128 v[84:87], v1 offset:25600
    v_mfma_f32_32x32x16_bf16 v[32:47], a[196:199], v[92:95], v[32:47]
    s_waitcnt lgkmcnt(2)
    v_mfma_f32_32x32x16_bf16 v[16:31], a[88:91], a[248:251], v[16:31]
    buffer_load_dwordx4 v1, s[40:43], s12 offen offset:1024 sc1 lds
    ds_read_b128 v[88:91], v1 offset:26624
    v_mfma_f32_32x32x16_bf16 v[32:47], a[200:203], a[248:251], v[32:47]
    v_mfma_f32_32x32x16_bf16 v[16:31], a[92:95], a[252:255], v[16:31]
    buffer_load_dwordx4 v1, s[40:43], s12 offen offset:2048 sc1 lds
    ds_read_b128 v[92:95], v1 offset:27648
    v_mfma_f32_32x32x16_bf16 v[32:47], a[204:207], a[252:255], v[32:47]
    s_waitcnt lgkmcnt(2)
    v_mfma_f32_32x32x16_bf16 v[16:31], a[96:99], v[80:83], v[16:31]
    s_waitcnt vmcnt(14)
    s_barrier
    ds_read_b128 a[248:251], v1 offset:28672
    v_mfma_f32_32x32x16_bf16 v[32:47], a[208:211], v[80:83], v[32:47]
    s_add_u32 m0, s66, 0
    s_add_u32 s13, s45, 14336
    buffer_load_dwordx4 v251, s[32:35], s13 offen lds
    v_mfma_f32_32x32x16_bf16 v[16:31], a[100:103], v[84:87], v[16:31]
    ds_read_b128 a[252:255], v1 offset:29696
    ds_read_b128 v[96:99], v249 offset:0
    v_mfma_f32_32x32x16_bf16 v[32:47], a[212:215], v[84:87], v[32:47]
    buffer_load_dwordx4 v252, s[32:35], s13 offen offset:1024 lds
    s_waitcnt lgkmcnt(3)
    v_mfma_f32_32x32x16_bf16 v[16:31], a[104:107], v[88:91], v[16:31]
    ds_read_b128 v[80:83], v1 offset:30720
    v_mfma_f32_32x32x16_bf16 v[32:47], a[216:219], v[88:91], v[32:47]
    v_mfma_f32_32x32x16_bf16 v[16:31], a[108:111], v[92:95], v[16:31]
    ds_read_b128 v[84:87], v1 offset:31744
    v_mfma_f32_32x32x16_bf16 v[32:47], a[220:223], v[92:95], v[32:47]
    s_waitcnt lgkmcnt(2)
    s_nop 0
    v_mfma_f32_32x32x16_bf16 v[16:31], a[240:243], v[96:99], v[16:31]
    v_mfma_f32_32x32x16_bf16 v[32:47], a[244:247], v[96:99], v[32:47]
    s_add_u32 m0, s66, 2048
    s_add_u32 s13, s45, 28672
    buffer_load_dwordx4 v251, s[32:35], s13 offen lds
    v_mfma_f32_32x32x16_bf16 v[48:63], a[0:3], a[248:251], 0
    ds_read_b128 v[88:91], v1 offset:32768
    v_mfma_f32_32x32x16_bf16 v[64:79], a[112:115], a[248:251], 0
    ds_read_b64_tr_b16 v[128:129], v253 offset:4096
    ds_read_b64_tr_b16 v[132:133], v11 offset:4096
    buffer_load_dwordx4 v252, s[32:35], s13 offen offset:1024 lds
    v_mfma_f32_32x32x16_bf16 v[48:63], a[4:7], a[252:255], v[48:63]
    ds_read_b128 v[92:95], v1 offset:33792
    s_nop 0
    v_mul_f32 v32, v32, v16
    v_mul_f32 v16, v16, v98
    v_exp_f32 v16, v16
    s_barrier
    v_mfma_f32_32x32x16_bf16 v[64:79], a[116:119], a[252:255], v[64:79]
    ds_read_b64_tr_b16 v[136:137], v15 offset:4096
    ds_read_b64_tr_b16 v[140:141], v14 offset:4096
    v_mul_f32 v33, v33, v17
    v_mul_f32 v17, v17, v98
    s_waitcnt lgkmcnt(6)
    v_mfma_f32_32x32x16_bf16 v[48:63], a[8:11], v[80:83], v[48:63]
    ds_read_b128 a[248:251], v1 offset:34816
    v_exp_f32 v17, v17
    v_fma_f32 v16, v16, v99, v99
    v_rcp_f32 v16, v16
    v_mfma_f32_32x32x16_bf16 v[64:79], a[120:123], v[80:83], v[64:79]
    v_mul_f32 v34, v34, v18
    v_mul_f32 v18, v18, v98
    ds_read_b64_tr_b16 v[130:131], v253 offset:6144
    ds_read_b64_tr_b16 v[134:135], v11 offset:6144
    v_mfma_f32_32x32x16_bf16 v[48:63], a[12:15], v[84:87], v[48:63]
    ds_read_b128 a[252:255], v1 offset:35840
    v_exp_f32 v18, v18
    v_fma_f32 v17, v17, v99, v99
    v_rcp_f32 v17, v17
    v_mfma_f32_32x32x16_bf16 v[64:79], a[124:127], v[84:87], v[64:79]
    ds_read_b64_tr_b16 v[138:139], v15 offset:6144
    ds_read_b64_tr_b16 v[142:143], v14 offset:6144
    s_waitcnt lgkmcnt(6)
    s_add_u32 m0, s66, 4096
    s_add_u32 s13, s45, 43008
    buffer_load_dwordx4 v251, s[32:35], s13 offen lds
    v_mfma_f32_32x32x16_bf16 v[48:63], a[16:19], v[88:91], v[48:63]
    ds_read_b128 v[80:83], v1 offset:36864
    v_mul_f32 v32, v32, v16
    v_mul_f32 v35, v35, v19
    v_mul_f32 v19, v19, v98
    v_exp_f32_e64 v19, v19
    v_mfma_f32_32x32x16_bf16 v[64:79], a[128:131], v[88:91], v[64:79]
    v_fma_f32 v18, v18, v99, v99
    ds_read_b64_tr_b16 v[144:145], v253 offset:8192
    ds_read_b64_tr_b16 v[148:149], v11 offset:8192
    buffer_load_dwordx4 v252, s[32:35], s13 offen offset:1024 lds
    v_mfma_f32_32x32x16_bf16 v[48:63], a[20:23], v[92:95], v[48:63]
    ds_read_b128 v[84:87], v1 offset:37888
    v_rcp_f32 v18, v18
    v_mul_f32 v33, v33, v17
    v_cvt_pk_bf16_f32 v16, v32, v33
    v_mul_f32 v40, v40, v24
    v_mfma_f32_32x32x16_bf16 v[64:79], a[132:135], v[92:95], v[64:79]
    ds_read_b64_tr_b16 v[152:153], v15 offset:8192
    ds_read_b64_tr_b16 v[156:157], v14 offset:8192
    s_add_u32 m0, s100, 0
    s_add_u32 s13, s48, 28672
    buffer_load_dwordx4 v251, s[32:35], s13 offen lds
    s_waitcnt lgkmcnt(8)
    v_mfma_f32_32x32x16_bf16 v[48:63], a[24:27], a[248:251], v[48:63]
    ds_read_b128 v[88:91], v1 offset:38912
    v_mul_f32 v24, v24, v98
    v_exp_f32 v24, v24
    v_fma_f32 v19, v19, v99, v99
    v_mfma_f32_32x32x16_bf16 v[64:79], a[136:139], a[248:251], v[64:79]
    buffer_load_dwordx4 v252, s[32:35], s13 offen offset:1024 lds
    v_rcp_f32 v19, v19
    v_mul_f32 v34, v34, v18
    v_mul_f32 v41, v41, v25
    v_mul_f32 v25, v25, v98
    v_mfma_f32_32x32x16_bf16 v[48:63], a[28:31], a[252:255], v[48:63]
    ds_read_b128 v[92:95], v1 offset:39936
    v_exp_f32 v25, v25
    v_fma_f32 v24, v24, v99, v99
    v_rcp_f32 v24, v24
    v_mfma_f32_32x32x16_bf16 v[64:79], a[140:143], a[252:255], v[64:79]
    v_mul_f32 v35, v35, v19
    s_waitcnt lgkmcnt(8)
    s_add_u32 m0, s66, 6144
    s_add_u32 s13, s46, 0
    buffer_load_dwordx4 v251, s[32:35], s13 offen lds
    s_waitcnt lgkmcnt(4)
    v_mfma_f32_32x32x16_bf16 v[48:63], a[32:35], v[80:83], v[48:63]
    ds_read_b128 a[248:251], v1 offset:40960
    v_cvt_pk_bf16_f32 v17, v34, v35
    v_mul_f32 v42, v42, v26
    v_mul_f32 v26, v26, v98
    v_exp_f32 v26, v26
    v_mfma_f32_32x32x16_bf16 v[64:79], a[144:147], v[80:83], v[64:79]
    buffer_load_dwordx4 v252, s[32:35], s13 offen offset:1024 lds
    v_fma_f32 v25, v25, v99, v99
    v_rcp_f32 v25, v25
    v_mul_f32 v40, v40, v24
    v_mul_f32 v43, v43, v27
    v_mfma_f32_32x32x16_bf16 v[48:63], a[36:39], v[84:87], v[48:63]
    ds_read_b128 a[252:255], v1 offset:41984
    v_mul_f32 v27, v27, v98
    v_exp_f32 v27, v27
    v_fma_f32 v26, v26, v99, v99
    v_mfma_f32_32x32x16_bf16 v[64:79], a[148:151], v[84:87], v[64:79]
    s_add_u32 m0, s100, 2048
    s_add_u32 s13, s48, 43008
    buffer_load_dwordx4 v251, s[32:35], s13 offen lds
    v_rcp_f32 v26, v26
    s_waitcnt lgkmcnt(2)
    v_mfma_f32_32x32x16_bf16 v[48:63], a[40:43], v[88:91], v[48:63]
    ds_read_b128 v[80:83], v1 offset:43008
    v_mul_f32 v41, v41, v25
    v_cvt_pk_bf16_f32 v18, v40, v41
    v_mul_f32 v36, v36, v20
    v_mul_f32 v20, v20, v98
    v_mfma_f32_32x32x16_bf16 v[64:79], a[152:155], v[88:91], v[64:79]
    v_exp_f32 v20, v20
    s_waitcnt vmcnt(9)
    ds_read_b64_tr_b16 v[146:147], v253 offset:0
    ds_read_b64_tr_b16 v[150:151], v11 offset:0
    buffer_load_dwordx4 v252, s[32:35], s13 offen offset:1024 lds
    v_mfma_f32_32x32x16_bf16 v[48:63], a[44:47], v[92:95], v[48:63]
    ds_read_b64_tr_b16 v[154:155], v15 offset:0
    ds_read_b64_tr_b16 v[158:159], v14 offset:0
    ds_read_b128 v[84:87], v1 offset:44032
    v_fma_f32 v27, v27, v99, v99
    v_rcp_f32 v27, v27
    v_mfma_f32_32x32x16_bf16 v[64:79], a[156:159], v[92:95], v[64:79]
    v_mul_f32 v42, v42, v26
    s_add_u32 m0, s66, 8192
    s_add_u32 s13, s46, 14336
    buffer_load_dwordx4 v251, s[32:35], s13 offen lds
    s_waitcnt lgkmcnt(6)
    v_mfma_f32_32x32x16_bf16 v[48:63], a[48:51], a[248:251], v[48:63]
    ds_read_b128 v[88:91], v1 offset:45056
    v_mul_f32 v37, v37, v21
    v_mul_f32 v21, v21, v98
    v_exp_f32 v21, v21
    v_fma_f32 v20, v20, v99, v99
    v_mfma_f32_32x32x16_bf16 v[64:79], a[160:163], a[248:251], v[64:79]
    buffer_load_dwordx4 v252, s[32:35], s13 offen offset:1024 lds
    v_rcp_f32 v20, v20
    v_mul_f32 v43, v43, v27
    v_cvt_pk_bf16_f32 v19, v42, v43
    s_add_u32 s27, s64, 0
    v_mfma_f32_32x32x16_bf16 v[48:63], a[52:55], a[252:255], v[48:63]
    ds_read_b128 v[92:95], v1 offset:46080
    buffer_store_dwordx4 v[16:19], v1, s[40:43], s27 offen offset:0 sc1
    v_mul_f32 v38, v38, v22
    v_mul_f32 v22, v22, v98
    v_mfma_f32_32x32x16_bf16 v[64:79], a[164:167], a[252:255], v[64:79]
    s_add_u32 m0, s100, 4096
    s_add_u32 s13, s49, 0
    buffer_load_dwordx4 v251, s[32:35], s13 offen lds
    v_exp_f32 v22, v22
    s_waitcnt lgkmcnt(2)
    v_mfma_f32_32x32x16_bf16 v[48:63], a[56:59], v[80:83], v[48:63]
    ds_read_b128 a[248:251], v1 offset:47104
    v_fma_f32 v21, v21, v99, v99
    v_rcp_f32 v21, v21
    v_mul_f32 v36, v36, v20
    v_mul_f32 v39, v39, v23
    v_mfma_f32_32x32x16_bf16 v[64:79], a[168:171], v[80:83], v[64:79]
    v_mul_f32 v23, v23, v98
    s_waitcnt vmcnt(12)
    ds_read_b64_tr_b16 v[160:161], v253 offset:2048
    ds_read_b64_tr_b16 v[164:165], v11 offset:2048
    buffer_load_dwordx4 v252, s[32:35], s13 offen offset:1024 lds
    v_mfma_f32_32x32x16_bf16 v[48:63], a[60:63], v[84:87], v[48:63]
    ds_read_b64_tr_b16 v[168:169], v15 offset:2048
    ds_read_b64_tr_b16 v[172:173], v14 offset:2048
    ds_read_b128 a[252:255], v1 offset:48128
    v_exp_f32 v23, v23
    v_fma_f32 v22, v22, v99, v99
    v_mfma_f32_32x32x16_bf16 v[64:79], a[172:175], v[84:87], v[64:79]
    s_add_u32 m0, s66, 0
    s_add_u32 s13, s46, 28672
    buffer_load_dwordx4 v251, s[32:35], s13 offen lds
    s_waitcnt lgkmcnt(6)
    v_mfma_f32_32x32x16_bf16 v[48:63], a[64:67], v[88:91], v[48:63]
    ds_read_b128 v[80:83], v1 offset:49152
    v_rcp_f32 v22, v22
    v_mul_f32 v37, v37, v21
    v_cvt_pk_bf16_f32 v20, v36, v37
    v_mul_f32 v44, v44, v28
    v_mfma_f32_32x32x16_bf16 v[64:79], a[176:179], v[88:91], v[64:79]
    buffer_load_dwordx4 v252, s[32:35], s13 offen offset:1024 lds
    v_mul_f32 v28, v28, v98
    v_exp_f32 v28, v28
    v_fma_f32 v23, v23, v99, v99
    v_mfma_f32_32x32x16_bf16 v[48:63], a[68:71], v[92:95], v[48:63]
    ds_read_b128 v[84:87], v1 offset:50176
    v_rcp_f32 v23, v23
    v_mul_f32 v38, v38, v22
    v_mul_f32 v45, v45, v29
    v_mul_f32 v29, v29, v98
    v_mfma_f32_32x32x16_bf16 v[64:79], a[180:183], v[92:95], v[64:79]
    v_exp_f32 v29, v29
    v_fma_f32 v28, v28, v99, v99
    v_rcp_f32 v28, v28
    s_waitcnt lgkmcnt(2)
    v_mfma_f32_32x32x16_bf16 v[48:63], a[72:75], a[248:251], v[48:63]
    ds_read_b128 v[88:91], v1 offset:51200
    v_mul_f32 v39, v39, v23
    v_cvt_pk_bf16_f32 v21, v38, v39
    v_mul_f32 v46, v46, v30
    v_mul_f32 v30, v30, v98
    v_mfma_f32_32x32x16_bf16 v[64:79], a[184:187], a[248:251], v[64:79]
    v_exp_f32 v30, v30
    v_fma_f32 v29, v29, v99, v99
    s_waitcnt vmcnt(13)
    ds_read_b64_tr_b16 v[162:163], v253 offset:4096
    ds_read_b64_tr_b16 v[166:167], v11 offset:4096
    v_mfma_f32_32x32x16_bf16 v[48:63], a[76:79], a[252:255], v[48:63]
    ds_read_b64_tr_b16 v[170:171], v15 offset:4096
    ds_read_b64_tr_b16 v[174:175], v14 offset:4096
    ds_read_b128 v[92:95], v1 offset:52224
    v_rcp_f32 v29, v29
    v_mul_f32 v44, v44, v28
    v_mfma_f32_32x32x16_bf16 v[64:79], a[188:191], a[252:255], v[64:79]
    v_mul_f32 v47, v47, v31
    s_add_u32 m0, s66, 2048
    s_add_u32 s13, s46, 43008
    buffer_load_dwordx4 v251, s[32:35], s13 offen lds
    s_waitcnt lgkmcnt(6)
    v_mfma_f32_32x32x16_bf16 v[48:63], a[80:83], v[80:83], v[48:63]
    ds_read_b128 a[248:251], v1 offset:53248
    v_mul_f32 v31, v31, v98
    v_exp_f32 v31, v31
    v_fma_f32 v30, v30, v99, v99
    v_mfma_f32_32x32x16_bf16 v[64:79], a[192:195], v[80:83], v[64:79]
    buffer_load_dwordx4 v252, s[32:35], s13 offen offset:1024 lds
    v_rcp_f32 v30, v30
    v_mul_f32 v45, v45, v29
    v_cvt_pk_bf16_f32 v22, v44, v45
    v_fma_f32 v31, v31, v99, v99
    v_mfma_f32_32x32x16_bf16 v[48:63], a[84:87], v[84:87], v[48:63]
    ds_read_b128 a[252:255], v1 offset:54272
    v_rcp_f32 v31, v31
    v_mul_f32 v46, v46, v30
    v_mul_f32 v47, v47, v31
    v_cvt_pk_bf16_f32 v23, v46, v47
    v_mfma_f32_32x32x16_bf16 v[64:79], a[196:199], v[84:87], v[64:79]
    buffer_store_dwordx4 v[20:23], v1, s[40:43], s27 offen offset:1024 sc1
    v_lshrrev_b32 v2, 4, v0
    v_xor_b32 v2, v2, v0
    s_waitcnt lgkmcnt(2)
    v_mfma_f32_32x32x16_bf16 v[48:63], a[88:91], v[88:91], v[48:63]
    ds_read_b128 v[80:83], v1 offset:55296
    v_and_b32 v2, 7, v2
    v_lshlrev_b32 v2, 4, v2
    v_and_b32 v3, 15, v0
    v_lshl_add_u32 v2, v3, 8, v2
    s_lshl_b32 s26, s3, 6
    v_mfma_f32_32x32x16_bf16 v[64:79], a[200:203], v[88:91], v[64:79]
    v_xor_b32 v2, s26, v2
    s_lshl_b32 s26, s3, 12
    s_add_u32 s26, s26, 57344
    s_waitcnt vmcnt(12)
    ds_read_b64_tr_b16 v[176:177], v253 offset:6144
    ds_read_b64_tr_b16 v[180:181], v11 offset:6144
    v_mfma_f32_32x32x16_bf16 v[48:63], a[92:95], v[92:95], v[48:63]
    ds_read_b64_tr_b16 v[184:185], v15 offset:6144
    ds_read_b64_tr_b16 v[188:189], v14 offset:6144
    ds_read_b128 v[84:87], v1 offset:56320
    v_add_u32 v5, s26, v2
    v_xor_b32 v6, 64, v5
    v_xor_b32 v7, 128, v5
    v_mfma_f32_32x32x16_bf16 v[64:79], a[204:207], v[92:95], v[64:79]
    v_xor_b32 v8, 192, v5
    s_add_u32 m0, s66, 4096
    s_add_u32 s13, s47, 0
    buffer_load_dwordx4 v251, s[32:35], s13 offen lds
    s_waitcnt lgkmcnt(6)
    v_mfma_f32_32x32x16_bf16 v[48:63], a[96:99], a[248:251], v[48:63]
    s_lshl_b32 s26, s3, 1
    v_lshrrev_b32 v2, 5, v0
    v_add_u32 v2, s26, v2
    s_barrier
    ds_read_b128 v[88:91], v248 offset:0
    v_mfma_f32_32x32x16_bf16 v[64:79], a[208:211], a[248:251], v[64:79]
    buffer_load_dwordx4 v252, s[32:35], s13 offen offset:1024 lds
    v_and_b32 v3, 7, v0
    v_bfe_u32 v4, v0, 4, 1
    v_lshl_add_u32 v12, v3, 1, v4
    v_xor_b32 v12, v12, v2
    v_lshlrev_b32_e64 v12, 4, v12
    v_mfma_f32_32x32x16_bf16 v[48:63], a[100:103], a[252:255], v[48:63]
    ds_read_b128 v[92:95], v248 offset:1024
    ds_read_b128 v[100:103], v249 offset:1024
    v_and_or_b32 v2, v0, 8, v2
    v_lshl_add_u32 v12, v2, 8, v12
    v_add_u32 v12, 57344, v12
    v_lshl_add_u32 v2, v4, 5, v2
    v_mfma_f32_32x32x16_bf16 v[64:79], a[212:215], a[252:255], v[64:79]
    s_lshl_b32 s26, s80, 4
    v_add_u32 v2, s26, v2
    v_mul_u32_u24 v2, 896, v2
    v_lshl_add_u32 v4, v3, 4, v2
    v_bfe_u32 v3, v0, 4, 1
    s_waitcnt lgkmcnt(3)
    v_mfma_f32_32x32x16_bf16 v[48:63], a[104:107], v[80:83], v[48:63]
    ds_read_b128 a[248:251], v248 offset:2048
    v_lshlrev_b32 v3, 9, v3
    v_and_b32 v2, 15, v0
    v_lshl_add_u32 v3, v2, 4, v3
    s_lshl_b32 s26, s80, 8
    v_add_u32 v3, s26, v3
    v_mfma_f32_32x32x16_bf16 v[64:79], a[216:219], v[80:83], v[64:79]
    v_lshrrev_b32 v2, 5, v0
    v_lshl_add_u32 v9, v2, 10, v3
    v_lshl_add_u32 v10, v2, 3, v3
    s_waitcnt vmcnt(10)
    s_nop 0
    ds_read_b64_tr_b16 v[178:179], v253 offset:8192
    ds_read_b64_tr_b16 v[182:183], v11 offset:8192
    v_mfma_f32_32x32x16_bf16 v[48:63], a[108:111], v[84:87], v[48:63]
    ds_read_b64_tr_b16 v[186:187], v15 offset:8192
    ds_read_b64_tr_b16 v[190:191], v14 offset:8192
    ds_read_b128 a[252:255], v248 offset:3072
    v_mfma_f32_32x32x16_bf16 v[64:79], a[220:223], v[84:87], v[64:79]
    s_add_u32 m0, s66, 6144
    s_add_u32 s13, s47, 14336
    buffer_load_dwordx4 v251, s[32:35], s13 offen lds
    s_waitcnt lgkmcnt(6)
    v_mfma_f32_32x32x16_bf16 v[48:63], a[240:243], v[100:103], v[48:63]
    v_mfma_f32_32x32x16_bf16 v[64:79], a[244:247], v[100:103], v[64:79]
    buffer_load_dwordx4 v252, s[32:35], s13 offen offset:1024 lds
    v_mfma_f32_32x32x16_bf16 v[16:31], a[0:3], v[88:91], 0
    ds_read_b128 v[80:83], v248 offset:4096
    v_mfma_f32_32x32x16_bf16 v[32:47], a[112:115], v[88:91], 0
    v_mfma_f32_32x32x16_bf16 v[16:31], a[4:7], v[92:95], v[16:31]
    ds_read_b128 v[84:87], v248 offset:5120
    s_nop 5
    v_mul_f32 v64, v64, v48
    v_mul_f32 v48, v48, v102
    v_exp_f32 v48, v48
    s_barrier
    v_mfma_f32_32x32x16_bf16 v[32:47], a[116:119], v[92:95], v[32:47]
    v_mul_f32 v65, v65, v49
    v_mul_f32 v49, v49, v102
    s_waitcnt vmcnt(7)
    ds_read_b64_tr_b16 v[192:193], v253 offset:0
    ds_read_b64_tr_b16 v[196:197], v11 offset:0
    s_waitcnt lgkmcnt(4)
    v_mfma_f32_32x32x16_bf16 v[16:31], a[8:11], a[248:251], v[16:31]
    ds_read_b64_tr_b16 v[200:201], v15 offset:0
    ds_read_b64_tr_b16 v[204:205], v14 offset:0
    ds_read_b128 v[88:91], v248 offset:6144
    v_exp_f32 v49, v49
    v_fma_f32 v48, v48, v103, v103
    v_mfma_f32_32x32x16_bf16 v[32:47], a[120:123], a[248:251], v[32:47]
    v_rcp_f32 v48, v48
    s_add_u32 m0, s66, 8192
    s_add_u32 s13, s47, 28672
    buffer_load_dwordx4 v251, s[32:35], s13 offen lds
    v_mfma_f32_32x32x16_bf16 v[16:31], a[12:15], a[252:255], v[16:31]
    ds_read_b128 v[92:95], v248 offset:7168
    v_mul_f32 v66, v66, v50
    v_mul_f32 v50, v50, v102
    v_exp_f32 v50, v50
    v_fma_f32 v49, v49, v103, v103
    v_mfma_f32_32x32x16_bf16 v[32:47], a[124:127], a[252:255], v[32:47]
    buffer_load_dwordx4 v252, s[32:35], s13 offen offset:1024 lds
    v_rcp_f32 v49, v49
    v_mul_f32 v64, v64, v48
    v_mul_f32 v67, v67, v51
    s_waitcnt lgkmcnt(6)
    v_mfma_f32_32x32x16_bf16 v[16:31], a[16:19], v[80:83], v[16:31]
    ds_read_b128 a[248:251], v248 offset:8192
    v_mul_f32 v51, v51, v102
    v_exp_f32 v51, v51
    v_fma_f32 v50, v50, v103, v103
    v_mfma_f32_32x32x16_bf16 v[32:47], a[128:131], v[80:83], v[32:47]
    s_add_u32 m0, s100, 28672
    s_add_u32 s13, s49, 14336
    buffer_load_dwordx4 v251, s[32:35], s13 offen lds
    v_rcp_f32 v50, v50
    v_mul_f32 v65, v65, v49
    v_mfma_f32_32x32x16_bf16 v[16:31], a[20:23], v[84:87], v[16:31]
    ds_read_b128 a[252:255], v248 offset:9216
    v_cvt_pk_bf16_f32 v48, v64, v65
    v_mul_f32 v72, v72, v56
    v_mul_f32 v56, v56, v102
    v_exp_f32 v56, v56
    v_mfma_f32_32x32x16_bf16 v[32:47], a[132:135], v[84:87], v[32:47]
    v_fma_f32 v51, v51, v103, v103
    s_waitcnt vmcnt(8)
    ds_read_b64_tr_b16 v[194:195], v253 offset:2048
    ds_read_b64_tr_b16 v[198:199], v11 offset:2048
    buffer_load_dwordx4 v252, s[32:35], s13 offen offset:1024 lds
    s_waitcnt lgkmcnt(4)
    v_mfma_f32_32x32x16_bf16 v[16:31], a[24:27], v[88:91], v[16:31]
    ds_read_b64_tr_b16 v[202:203], v15 offset:2048
    ds_read_b64_tr_b16 v[206:207], v14 offset:2048
    ds_read_b128 v[80:83], v248 offset:10240
    v_rcp_f32 v51, v51
    v_mul_f32 v66, v66, v50
    v_mfma_f32_32x32x16_bf16 v[32:47], a[136:139], v[88:91], v[32:47]
    v_mul_f32 v73, v73, v57
    v_mul_f32 v57, v57, v102
    s_add_u32 m0, s66, 0
    s_add_u32 s13, s47, 43008
    buffer_load_dwordx4 v251, s[32:35], s13 offen lds
    v_mfma_f32_32x32x16_bf16 v[16:31], a[28:31], v[92:95], v[16:31]
    ds_read_b128 v[84:87], v248 offset:11264
    v_exp_f32 v57, v57
    v_fma_f32 v56, v56, v103, v103
    v_rcp_f32 v56, v56
    v_mfma_f32_32x32x16_bf16 v[32:47], a[140:143], v[92:95], v[32:47]
    buffer_load_dwordx4 v252, s[32:35], s13 offen offset:1024 lds
    v_mul_f32 v67, v67, v51
    v_cvt_pk_bf16_f32 v49, v66, v67
    v_mul_f32 v74, v74, v58
    v_mul_f32 v58, v58, v102
    s_waitcnt lgkmcnt(6)
    v_mfma_f32_32x32x16_bf16 v[16:31], a[32:35], a[248:251], v[16:31]
    ds_read_b128 v[88:91], v248 offset:12288
    v_exp_f32 v58, v58
    v_fma_f32 v57, v57, v103, v103
    v_rcp_f32 v57, v57
    v_mfma_f32_32x32x16_bf16 v[32:47], a[144:147], a[248:251], v[32:47]
    s_add_u32 m0, s100, 30720
    s_add_u32 s13, s49, 28672
    buffer_load_dwordx4 v251, s[32:35], s13 offen lds
    v_mul_f32 v72, v72, v56
    v_mul_f32 v75, v75, v59
    v_mul_f32 v59, v59, v102
    v_mfma_f32_32x32x16_bf16 v[16:31], a[36:39], a[252:255], v[16:31]
    ds_read_b128 v[92:95], v248 offset:13312
    v_exp_f32 v59, v59
    v_fma_f32 v58, v58, v103, v103
    v_rcp_f32 v58, v58
    v_mfma_f32_32x32x16_bf16 v[32:47], a[148:151], a[252:255], v[32:47]
    v_mul_f32 v73, v73, v57
    s_waitcnt vmcnt(9)
    ds_read_b64_tr_b16 v[208:209], v253 offset:4096
    ds_read_b64_tr_b16 v[212:213], v11 offset:4096
    buffer_load_dwordx4 v252, s[32:35], s13 offen offset:1024 lds
    s_waitcnt lgkmcnt(4)
    v_mfma_f32_32x32x16_bf16 v[16:31], a[40:43], v[80:83], v[16:31]
L_pad5:
    s_cbranch_execz L_hopret
    ds_read_b64_tr_b16 v[216:217], v15 offset:4096
    ds_read_b64_tr_b16 v[220:221], v14 offset:4096
    ds_read_b128 a[248:251], v248 offset:14336
    v_cvt_pk_bf16_f32 v50, v72, v73
    v_mul_f32 v68, v68, v52
    v_mul_f32 v52, v52, v102
    v_mfma_f32_32x32x16_bf16 v[32:47], a[152:155], v[80:83], v[32:47]
    v_exp_f32 v52, v52
    s_add_u32 m0, s66, 2048
    s_add_u32 s13, s48, 0
    buffer_load_dwordx4 v251, s[32:35], s13 offen lds
    v_mfma_f32_32x32x16_bf16 v[16:31], a[44:47], v[84:87], v[16:31]
    ds_read_b128 a[252:255], v248 offset:15360
    v_fma_f32 v59, v59, v103, v103
    v_rcp_f32 v59, v59
    v_mul_f32 v74, v74, v58
    v_mul_f32 v69, v69, v53
    v_mfma_f32_32x32x16_bf16 v[32:47], a[156:159], v[84:87], v[32:47]
    buffer_load_dwordx4 v252, s[32:35], s13 offen offset:1024 lds
    v_mul_f32 v53, v53, v102
    v_exp_f32 v53, v53
    v_fma_f32 v52, v52, v103, v103
    s_waitcnt lgkmcnt(6)
    v_mfma_f32_32x32x16_bf16 v[16:31], a[48:51], v[88:91], v[16:31]
    ds_read_b128 v[80:83], v248 offset:16384
    v_rcp_f32 v52, v52
    v_mul_f32 v75, v75, v59
    v_cvt_pk_bf16_f32 v51, v74, v75
    s_add_u32 s27, s64, 229376
    v_mfma_f32_32x32x16_bf16 v[32:47], a[160:163], v[88:91], v[32:47]
    s_add_u32 s12, s69, 0
    buffer_load_dwordx2 v[104:105], v10, s[40:43], s12 offen sc1
    buffer_store_dwordx4 v[48:51], v1, s[40:43], s27 offen offset:0 sc1
    v_mul_f32 v70, v70, v54
    v_mfma_f32_32x32x16_bf16 v[16:31], a[52:55], v[92:95], v[16:31]
    ds_read_b128 v[84:87], v248 offset:17408
    v_mul_f32 v54, v54, v102
    v_exp_f32 v54, v54
    v_fma_f32 v53, v53, v103, v103
    v_mfma_f32_32x32x16_bf16 v[32:47], a[164:167], v[92:95], v[32:47]
    s_waitcnt vmcnt(12)
    ds_read_b64_tr_b16 v[210:211], v253 offset:6144
    ds_read_b64_tr_b16 v[214:215], v11 offset:6144
    s_add_u32 s12, s69, 65536
    buffer_load_dwordx2 v[106:107], v10, s[40:43], s12 offen sc1
    s_waitcnt lgkmcnt(4)
    v_mfma_f32_32x32x16_bf16 v[16:31], a[56:59], a[248:251], v[16:31]
    ds_read_b64_tr_b16 v[218:219], v15 offset:6144
    ds_read_b64_tr_b16 v[222:223], v14 offset:6144
    ds_read_b128 v[88:91], v248 offset:18432
    v_rcp_f32 v53, v53
    v_mul_f32 v68, v68, v52
    v_mfma_f32_32x32x16_bf16 v[32:47], a[168:171], a[248:251], v[32:47]
    v_mul_f32 v71, v71, v55
    v_mul_f32 v55, v55, v102
    s_add_u32 m0, s66, 4096
    s_add_u32 s13, s48, 14336
    buffer_load_dwordx4 v251, s[32:35], s13 offen lds
    v_mfma_f32_32x32x16_bf16 v[16:31], a[60:63], a[252:255], v[16:31]
    ds_read_b128 v[92:95], v248 offset:19456
    v_exp_f32 v55, v55
    v_fma_f32 v54, v54, v103, v103
    v_rcp_f32 v54, v54
    v_mfma_f32_32x32x16_bf16 v[32:47], a[172:175], a[252:255], v[32:47]
    buffer_load_dwordx4 v252, s[32:35], s13 offen offset:1024 lds
    v_mul_f32 v69, v69, v53
    v_cvt_pk_bf16_f32 v52, v68, v69
    v_mul_f32 v76, v76, v60
    v_mul_f32 v60, v60, v102
    s_waitcnt lgkmcnt(6)
    v_mfma_f32_32x32x16_bf16 v[16:31], a[64:67], v[80:83], v[16:31]
    ds_read_b128 a[248:251], v248 offset:20480
    v_exp_f32 v60, v60
    v_fma_f32 v55, v55, v103, v103
    v_rcp_f32 v55, v55
    v_mfma_f32_32x32x16_bf16 v[32:47], a[176:179], v[80:83], v[32:47]
    s_add_u32 s12, s69, 131072
    buffer_load_dwordx2 v[108:109], v10, s[40:43], s12 offen sc1
    v_mul_f32 v70, v70, v54
    v_mul_f32 v77, v77, v61
    v_mul_f32 v61, v61, v102
    v_mfma_f32_32x32x16_bf16 v[16:31], a[68:71], v[84:87], v[16:31]
    ds_read_b128 a[252:255], v248 offset:21504
    v_exp_f32 v61, v61
    v_fma_f32 v60, v60, v103, v103
    v_rcp_f32 v60, v60
    v_mfma_f32_32x32x16_bf16 v[32:47], a[180:183], v[84:87], v[32:47]
    s_waitcnt vmcnt(14)
    ds_read_b64_tr_b16 v[224:225], v253 offset:8192
    ds_read_b64_tr_b16 v[228:229], v11 offset:8192
    s_add_u32 s12, s69, 196608
    buffer_load_dwordx2 v[110:111], v10, s[40:43], s12 offen sc1
    s_waitcnt lgkmcnt(4)
    v_mfma_f32_32x32x16_bf16 v[16:31], a[72:75], v[88:91], v[16:31]
    ds_read_b64_tr_b16 v[232:233], v15 offset:8192
    ds_read_b64_tr_b16 v[236:237], v14 offset:8192
    ds_read_b128 v[80:83], v248 offset:22528
    v_mul_f32 v71, v71, v55
    v_cvt_pk_bf16_f32 v53, v70, v71
    v_mul_f32 v78, v78, v62
    v_mfma_f32_32x32x16_bf16 v[32:47], a[184:187], v[88:91], v[32:47]
    v_mul_f32 v62, v62, v102
    s_add_u32 m0, s66, 6144
    s_add_u32 s13, s49, 43008
    buffer_load_dwordx4 v251, s[32:35], s13 offen lds
    v_mfma_f32_32x32x16_bf16 v[16:31], a[76:79], v[92:95], v[16:31]
    ds_read_b128 v[84:87], v248 offset:23552
    v_exp_f32 v62, v62
    v_fma_f32 v61, v61, v103, v103
    v_rcp_f32 v61, v61
    v_mfma_f32_32x32x16_bf16 v[32:47], a[188:191], v[92:95], v[32:47]
    buffer_load_dwordx4 v252, s[32:35], s13 offen offset:1024 lds
    v_mul_f32 v76, v76, v60
    v_mul_f32 v79, v79, v63
    v_mul_f32 v63, v63, v102
    s_waitcnt lgkmcnt(6)
    v_mfma_f32_32x32x16_bf16 v[16:31], a[80:83], a[248:251], v[16:31]
    ds_read_b128 v[88:91], v248 offset:24576
    v_exp_f32 v63, v63
    v_fma_f32 v62, v62, v103, v103
    v_rcp_f32 v62, v62
    v_mfma_f32_32x32x16_bf16 v[32:47], a[192:195], a[248:251], v[32:47]
    v_mul_f32 v77, v77, v61
    v_cvt_pk_bf16_f32 v54, v76, v77
    v_fma_f32 v63, v63, v103, v103
    v_rcp_f32 v63, v63
    v_mul_f32 v78, v78, v62
    v_mfma_f32_32x32x16_bf16 v[16:31], a[84:87], a[252:255], v[16:31]
    ds_read_b128 v[92:95], v248 offset:25600
    v_mul_f32 v79, v79, v63
    v_cvt_pk_bf16_f32 v55, v78, v79
    buffer_store_dwordx4 v[52:55], v1, s[40:43], s27 offen offset:1024 sc1
    v_mfma_f32_32x32x16_bf16 v[32:47], a[196:199], a[252:255], v[32:47]
    s_waitcnt vmcnt(14)
    ds_read_b64_tr_b16 v[226:227], v253 offset:0
    ds_read_b64_tr_b16 v[230:231], v11 offset:0
    s_waitcnt lgkmcnt(4)
    v_mfma_f32_32x32x16_bf16 v[16:31], a[88:91], v[80:83], v[16:31]
    ds_read_b64_tr_b16 v[234:235], v15 offset:0
    ds_read_b64_tr_b16 v[238:239], v14 offset:0
    ds_read_b128 a[248:251], v248 offset:26624
    v_mfma_f32_32x32x16_bf16 v[32:47], a[200:203], v[80:83], v[32:47]
    s_add_u32 m0, s66, 8192
    s_add_u32 s13, s50, 0
    buffer_load_dwordx4 v251, s[32:35], s13 offen lds
    v_mfma_f32_32x32x16_bf16 v[16:31], a[92:95], v[84:87], v[16:31]
    ds_read_b128 a[252:255], v248 offset:27648
    v_mfma_f32_32x32x16_bf16 v[32:47], a[204:207], v[84:87], v[32:47]
    buffer_load_dwordx4 v252, s[32:35], s13 offen offset:1024 lds
    s_waitcnt lgkmcnt(6)
    v_mfma_f32_32x32x16_bf16 v[16:31], a[96:99], v[88:91], v[16:31]
    s_barrier
    ds_read_b128 v[80:83], v248 offset:28672
    v_mfma_f32_32x32x16_bf16 v[32:47], a[208:211], v[88:91], v[32:47]
    v_mfma_f32_32x32x16_bf16 v[16:31], a[100:103], v[92:95], v[16:31]
    ds_read_b128 v[84:87], v248 offset:29696
    ds_read_b128 v[96:99], v249 offset:2048
    v_mfma_f32_32x32x16_bf16 v[32:47], a[212:215], v[92:95], v[32:47]
    s_waitcnt vmcnt(12)
    ds_read_b64_tr_b16 a[224:225], v253 offset:2048
    ds_read_b64_tr_b16 a[228:229], v11 offset:2048
    s_waitcnt lgkmcnt(5)
    v_mfma_f32_32x32x16_bf16 v[16:31], a[104:107], a[248:251], v[16:31]
    ds_read_b64_tr_b16 a[232:233], v15 offset:2048
    ds_read_b64_tr_b16 a[236:237], v14 offset:2048
    ds_read_b128 v[88:91], v248 offset:30720
    v_mfma_f32_32x32x16_bf16 v[32:47], a[216:219], a[248:251], v[32:47]
    s_add_u32 m0, s66, 0
    s_add_u32 s13, s50, 14336
    buffer_load_dwordx4 v251, s[32:35], s13 offen lds
    v_mfma_f32_32x32x16_bf16 v[16:31], a[108:111], a[252:255], v[16:31]
    ds_read_b128 v[92:95], v248 offset:31744
    v_mfma_f32_32x32x16_bf16 v[32:47], a[220:223], a[252:255], v[32:47]
    buffer_load_dwordx4 v252, s[32:35], s13 offen offset:1024 lds
    s_waitcnt lgkmcnt(6)
    v_mfma_f32_32x32x16_bf16 v[16:31], a[240:243], v[96:99], v[16:31]
    v_mfma_f32_32x32x16_bf16 v[32:47], a[244:247], v[96:99], v[32:47]
    v_mfma_f32_32x32x16_bf16 v[48:63], a[0:3], v[80:83], 0
    ds_read_b128 a[248:251], v248 offset:32768
    v_mfma_f32_32x32x16_bf16 v[64:79], a[112:115], v[80:83], 0
    s_waitcnt vmcnt(9)
    ds_read_b64_tr_b16 a[226:227], v253 offset:4096
    ds_read_b64_tr_b16 a[230:231], v11 offset:4096
    v_mfma_f32_32x32x16_bf16 v[48:63], a[4:7], v[84:87], v[48:63]
    ds_read_b64_tr_b16 a[234:235], v15 offset:4096
    ds_read_b64_tr_b16 a[238:239], v14 offset:4096
    ds_read_b128 a[252:255], v248 offset:33792
    s_nop 1
    v_mul_f32 v32, v32, v16
    v_mul_f32 v16, v16, v98
    v_mfma_f32_32x32x16_bf16 v[64:79], a[116:119], v[84:87], v[64:79]
    s_waitcnt lgkmcnt(8)
    s_add_u32 m0, s66, 2048
    s_add_u32 s13, s50, 28672
    buffer_load_dwordx4 v251, s[32:35], s13 offen lds
    s_waitcnt lgkmcnt(6)
    v_mfma_f32_32x32x16_bf16 v[48:63], a[8:11], v[88:91], v[48:63]
    ds_read_b128 v[80:83], v248 offset:34816
    v_exp_f32 v16, v16
    v_mul_f32 v33, v33, v17
    v_mul_f32 v17, v17, v98
    v_mfma_f32_32x32x16_bf16 v[64:79], a[120:123], v[88:91], v[64:79]
    buffer_load_dwordx4 v252, s[32:35], s13 offen offset:1024 lds
    v_exp_f32 v17, v17
    v_fma_f32 v16, v16, v99, v99
    v_rcp_f32 v16, v16
    v_mfma_f32_32x32x16_bf16 v[48:63], a[12:15], v[92:95], v[48:63]
    s_waitcnt vmcnt(6)
    s_barrier
    s_cmp_lg_u32 s3, 0
    s_cbranch_scc1 L_w0_22
    s_mov_b32 s38, 0
    s_atomic_add s99, s[24:25], s87 offset:4096
L_w0_22:
    ds_read_b128 v[84:87], v248 offset:35840
    v_mfma_f32_32x32x16_bf16 v[64:79], a[124:127], v[92:95], v[64:79]
    v_mul_f32 v34, v34, v18
    v_mul_f32 v18, v18, v98
    v_exp_f32 v18, v18
    v_fma_f32 v17, v17, v99, v99
    s_waitcnt lgkmcnt(2)
    v_mfma_f32_32x32x16_bf16 v[48:63], a[16:19], a[248:251], v[48:63]
    ds_read_b128 v[88:91], v248 offset:36864
    v_rcp_f32 v17, v17
    v_mul_f32 v32, v32, v16
    v_mul_f32 v35, v35, v19
    v_mul_f32 v19, v19, v98
    v_mfma_f32_32x32x16_bf16 v[64:79], a[128:131], a[248:251], v[64:79]
    v_exp_f32 v19, v19
    v_fma_f32 v18, v18, v99, v99
    v_rcp_f32 v18, v18
    v_mul_f32 v33, v33, v17
    v_mfma_f32_32x32x16_bf16 v[48:63], a[20:23], a[252:255], v[48:63]
    ds_read_b128 v[92:95], v248 offset:37888
    v_cvt_pk_bf16_f32 v16, v32, v33
    v_mul_f32 v40, v40, v24
    v_mul_f32 v24, v24, v98
    v_exp_f32 v24, v24
    v_mfma_f32_32x32x16_bf16 v[64:79], a[132:135], a[252:255], v[64:79]
    v_fma_f32 v19, v19, v99, v99
    s_add_u32 m0, s66, 4096
    s_add_u32 s13, s50, 43008
    buffer_load_dwordx4 v251, s[32:35], s13 offen lds
    s_waitcnt lgkmcnt(2)
    v_mfma_f32_32x32x16_bf16 v[48:63], a[24:27], v[80:83], v[48:63]
    ds_read_b128 a[248:251], v248 offset:38912
    v_rcp_f32 v19, v19
    v_mul_f32 v34, v34, v18
    v_mul_f32 v41, v41, v25
    v_mul_f32 v25, v25, v98
    v_mfma_f32_32x32x16_bf16 v[64:79], a[136:139], v[80:83], v[64:79]
    buffer_load_dwordx4 v252, s[32:35], s13 offen offset:1024 lds
    v_exp_f32 v25, v25
    v_fma_f32 v24, v24, v99, v99
    v_rcp_f32 v24, v24
    v_mfma_f32_32x32x16_bf16 v[48:63], a[28:31], v[84:87], v[48:63]
    ds_read_b128 a[252:255], v248 offset:39936
    v_mul_f32 v35, v35, v19
    v_cvt_pk_bf16_f32 v17, v34, v35
    v_mul_f32 v42, v42, v26
    v_mul_f32 v26, v26, v98
    v_mfma_f32_32x32x16_bf16 v[64:79], a[140:143], v[84:87], v[64:79]
    v_exp_f32 v26, v26
    v_fma_f32 v25, v25, v99, v99
    v_rcp_f32 v25, v25
    s_waitcnt lgkmcnt(2)
    v_mfma_f32_32x32x16_bf16 v[48:63], a[32:35], v[88:91], v[48:63]
    ds_read_b128 v[80:83], v248 offset:40960
    v_mul_f32 v40, v40, v24
    v_mul_f32 v43, v43, v27
    v_mul_f32 v27, v27, v98
    v_exp_f32 v27, v27
    v_mfma_f32_32x32x16_bf16 v[64:79], a[144:147], v[88:91], v[64:79]
    v_fma_f32 v26, v26, v99, v99
    v_rcp_f32 v26, v26
    v_mul_f32 v41, v41, v25
    v_cvt_pk_bf16_f32 v18, v40, v41
    v_mul_f32 v36, v36, v20
    v_mfma_f32_32x32x16_bf16 v[48:63], a[36:39], v[92:95], v[48:63]
    ds_read_b128 v[84:87], v248 offset:41984
    v_mul_f32 v20, v20, v98
    v_exp_f32 v20, v20
    v_fma_f32 v27, v27, v99, v99
    v_mfma_f32_32x32x16_bf16 v[64:79], a[148:151], v[92:95], v[64:79]
    v_rcp_f32 v27, v27
    v_mul_f32 v42, v42, v26
    v_mul_f32 v37, v37, v21
    v_mul_f32 v21, v21, v98
    s_waitcnt lgkmcnt(2)
    v_mfma_f32_32x32x16_bf16 v[48:63], a[40:43], a[248:251], v[48:63]
    ds_read_b128 v[88:91], v248 offset:43008
    v_exp_f32 v21, v21
    v_fma_f32 v20, v20, v99, v99
    v_rcp_f32 v20, v20
    v_mfma_f32_32x32x16_bf16 v[64:79], a[152:155], a[248:251], v[64:79]
    s_cmp_lg_u32 s3, 0
    s_cbranch_scc1 L_w0_23
    s_atomic_umax s38, s[24:25], s87 offset:4096 glc
L_w0_23:
    v_mfma_f32_32x32x16_bf16 v[48:63], a[44:47], a[252:255], v[48:63]
    ds_read_b128 v[92:95], v248 offset:44032
    v_mul_f32 v43, v43, v27
    v_cvt_pk_bf16_f32 v19, v42, v43
    s_add_u32 s27, s64, 458752
    v_mfma_f32_32x32x16_bf16 v[64:79], a[156:159], a[252:255], v[64:79]
    buffer_store_dwordx4 v[16:19], v1, s[40:43], s27 offen offset:0 sc1
    v_mul_f32 v38, v38, v22
    v_mul_f32 v22, v22, v98
    s_waitcnt lgkmcnt(2)
    v_mfma_f32_32x32x16_bf16 v[48:63], a[48:51], v[80:83], v[48:63]
    ds_read_b128 a[248:251], v248 offset:45056
    v_exp_f32 v22, v22
    v_fma_f32 v21, v21, v99, v99
    v_rcp_f32 v21, v21
    v_mfma_f32_32x32x16_bf16 v[64:79], a[160:163], v[80:83], v[64:79]
    v_mul_f32 v36, v36, v20
    v_mul_f32 v39, v39, v23
    v_mul_f32 v23, v23, v98
    v_exp_f32 v23, v23
    v_fma_f32 v22, v22, v99, v99
    v_mfma_f32_32x32x16_bf16 v[48:63], a[52:55], v[84:87], v[48:63]
    ds_read_b128 a[252:255], v248 offset:46080
    v_rcp_f32 v22, v22
    v_mul_f32 v37, v37, v21
    v_cvt_pk_bf16_f32 v20, v36, v37
    v_mul_f32 v44, v44, v28
    v_mfma_f32_32x32x16_bf16 v[64:79], a[164:167], v[84:87], v[64:79]
    v_mul_f32 v28, v28, v98
    v_exp_f32 v28, v28
    v_fma_f32 v23, v23, v99, v99
    s_waitcnt lgkmcnt(2)
    v_mfma_f32_32x32x16_bf16 v[48:63], a[56:59], v[88:91], v[48:63]
    ds_read_b128 v[80:83], v248 offset:47104
    v_rcp_f32 v23, v23
    v_mul_f32 v38, v38, v22
    v_mul_f32 v45, v45, v29
    v_mul_f32 v29, v29, v98
    v_mfma_f32_32x32x16_bf16 v[64:79], a[168:171], v[88:91], v[64:79]
    v_exp_f32 v29, v29
    v_fma_f32 v28, v28, v99, v99
    v_rcp_f32 v28, v28
    v_mul_f32 v39, v39, v23
    v_mfma_f32_32x32x16_bf16 v[48:63], a[60:63], v[92:95], v[48:63]
    ds_read_b128 v[84:87], v248 offset:48128
    v_cvt_pk_bf16_f32 v21, v38, v39
    v_mul_f32 v46, v46, v30
    v_mul_f32 v30, v30, v98
    v_exp_f32 v30, v30
    v_mfma_f32_32x32x16_bf16 v[64:79], a[172:175], v[92:95], v[64:79]
    v_fma_f32 v29, v29, v99, v99
    v_rcp_f32 v29, v29
    v_mul_f32 v44, v44, v28
    v_mul_f32 v47, v47, v31
    s_waitcnt lgkmcnt(2)
    v_mfma_f32_32x32x16_bf16 v[48:63], a[64:67], a[248:251], v[48:63]
    ds_read_b128 v[88:91], v248 offset:49152
    v_mul_f32 v31, v31, v98
    v_exp_f32 v31, v31
    v_fma_f32 v30, v30, v99, v99
    v_mfma_f32_32x32x16_bf16 v[64:79], a[176:179], a[248:251], v[64:79]
    v_rcp_f32 v30, v30
    v_mul_f32 v45, v45, v29
    v_cvt_pk_bf16_f32 v22, v44, v45
    v_fma_f32 v31, v31, v99, v99
    v_mfma_f32_32x32x16_bf16 v[48:63], a[68:71], a[252:255], v[48:63]
    ds_read_b128 v[92:95], v248 offset:50176
    v_rcp_f32 v31, v31
    v_mul_f32 v46, v46, v30
    v_mul_f32 v47, v47, v31
    v_cvt_pk_bf16_f32 v23, v46, v47
    v_mfma_f32_32x32x16_bf16 v[64:79], a[180:183], a[252:255], v[64:79]
    buffer_store_dwordx4 v[20:23], v1, s[40:43], s27 offen offset:1024 sc1
    v_lshlrev_b32 v16, 16, v104
    s_waitcnt lgkmcnt(2)
    v_mfma_f32_32x32x16_bf16 v[48:63], a[72:75], v[80:83], v[48:63]
    ds_read_b128 a[248:251], v248 offset:51200
    v_and_b32 v17, 0xffff0000, v104
    v_lshlrev_b32 v18, 16, v105
    v_and_b32 v19, 0xffff0000, v105
    v_lshlrev_b32 v32, 16, v106
    v_mfma_f32_32x32x16_bf16 v[64:79], a[184:187], v[80:83], v[64:79]
    v_and_b32 v33, 0xffff0000, v106
    v_lshlrev_b32 v34, 16, v107
    v_and_b32 v35, 0xffff0000, v107
    v_mfma_f32_32x32x16_bf16 v[48:63], a[76:79], v[84:87], v[48:63]
    ds_read_b128 a[252:255], v248 offset:52224
    v_mfma_f32_32x32x16_bf16 v[64:79], a[188:191], v[84:87], v[64:79]
    s_waitcnt lgkmcnt(2)
    v_mfma_f32_32x32x16_bf16 v[48:63], a[80:83], v[88:91], v[48:63]
    s_cmp_eq_u32 s3, 0
    s_cselect_b32 s39, s38, 14
    s_cmp_lt_u32 s39, 14
    s_cbranch_scc1 L_slow_24
L_back_25:
    s_barrier
    ds_read_b128 v[80:83], v248 offset:53248
    v_mfma_f32_32x32x16_bf16 v[64:79], a[192:195], v[88:91], v[64:79]
    buffer_load_dwordx4 a[0:3], v9, s[40:43], s4 offen offset:0 sc1
    v_mfma_f32_32x32x16_bf16 v[48:63], a[84:87], v[92:95], v[48:63]
    ds_read_b128 v[84:87], v248 offset:54272
    v_mfma_f32_32x32x16_bf16 v[64:79], a[196:199], v[92:95], v[64:79]
    buffer_load_dwordx4 a[4:7], v9, s[40:43], s4 offen offset:2048 sc1
    s_waitcnt lgkmcnt(2)
    s_nop 0
    v_mfma_f32_32x32x16_bf16 v[48:63], a[88:91], a[248:251], v[48:63]
    ds_read_b64_tr_b16 a[112:113], v243 offset:0
    ds_read_b64_tr_b16 a[116:117], v244 offset:0
    ds_read_b128 v[88:91], v248 offset:55296
    v_mfma_f32_32x32x16_bf16 v[64:79], a[200:203], a[248:251], v[64:79]
    ds_read_b64_tr_b16 a[120:121], v246 offset:0
    ds_read_b64_tr_b16 a[124:125], v247 offset:0
    buffer_load_dwordx4 a[8:11], v9, s[40:43], s5 offen offset:0 sc1
    v_mfma_f32_32x32x16_bf16 v[48:63], a[92:95], a[252:255], v[48:63]
    ds_read_b64_tr_b16 a[114:115], v243 offset:2048
    ds_read_b64_tr_b16 a[118:119], v244 offset:2048
    ds_read_b128 v[92:95], v248 offset:56320
    v_mfma_f32_32x32x16_bf16 v[64:79], a[204:207], a[252:255], v[64:79]
    ds_read_b64_tr_b16 a[122:123], v246 offset:2048
    ds_read_b64_tr_b16 a[126:127], v247 offset:2048
    buffer_load_dwordx4 a[12:15], v9, s[40:43], s5 offen offset:2048 sc1
    s_waitcnt lgkmcnt(10)
    s_nop 0
    v_mfma_f32_32x32x16_bf16 v[48:63], a[96:99], v[80:83], v[48:63]
    ds_read_b64_tr_b16 a[128:129], v243 offset:4096
    ds_read_b64_tr_b16 a[132:133], v244 offset:4096
    v_mfma_f32_32x32x16_bf16 v[64:79], a[208:211], v[80:83], v[64:79]
    ds_read_b64_tr_b16 a[136:137], v246 offset:4096
    ds_read_b64_tr_b16 a[140:141], v247 offset:4096
    buffer_load_dwordx4 a[16:19], v9, s[40:43], s6 offen offset:0 sc1
    v_mfma_f32_32x32x16_bf16 v[48:63], a[100:103], v[84:87], v[48:63]
    ds_read_b64_tr_b16 a[130:131], v243 offset:28672
    ds_read_b64_tr_b16 a[134:135], v244 offset:28672
    ds_read_b128 v[100:103], v249 offset:3072
    v_mfma_f32_32x32x16_bf16 v[64:79], a[212:215], v[84:87], v[64:79]
    ds_read_b64_tr_b16 a[138:139], v246 offset:28672
    ds_read_b64_tr_b16 a[142:143], v247 offset:28672
    buffer_load_dwordx4 a[20:23], v9, s[40:43], s6 offen offset:2048 sc1
    s_waitcnt lgkmcnt(11)
    s_nop 0
    v_mfma_f32_32x32x16_bf16 v[48:63], a[104:107], v[88:91], v[48:63]
    ds_read_b64_tr_b16 a[144:145], v243 offset:30720
    ds_read_b64_tr_b16 a[148:149], v244 offset:30720
    v_mfma_f32_32x32x16_bf16 v[64:79], a[216:219], v[88:91], v[64:79]
    ds_read_b64_tr_b16 a[152:153], v246 offset:30720
    ds_read_b64_tr_b16 a[156:157], v247 offset:30720
    buffer_load_dwordx4 a[24:27], v9, s[40:43], s7 offen offset:0 sc1
    v_mfma_f32_32x32x16_bf16 v[48:63], a[108:111], v[92:95], v[48:63]
    v_mfma_f32_32x32x16_bf16 v[64:79], a[220:223], v[92:95], v[64:79]
    buffer_load_dwordx4 a[28:31], v9, s[40:43], s7 offen offset:2048 sc1
    s_waitcnt lgkmcnt(6)
    v_mfma_f32_32x32x16_bf16 v[48:63], a[240:243], v[100:103], v[48:63]
    v_mfma_f32_32x32x16_bf16 v[64:79], a[244:247], v[100:103], v[64:79]
    buffer_load_dwordx4 a[32:35], v9, s[40:43], s8 offen offset:0 sc1
    s_waitcnt lgkmcnt(0)
    s_waitcnt vmcnt(9)
    s_barrier
    s_cmp_lg_u32 s3, 0
    s_cbranch_scc1 L_w0_26
    s_mov_b32 s38, 0
    s_atomic_add s99, s[24:25], s87 offset:5120
L_w0_26:
    buffer_load_dwordx4 a[36:39], v9, s[40:43], s8 offen offset:2048 sc1
    s_nop 4
    v_pk_mul_f32 v[64:65], v[64:65], v[48:49]
    v_pk_mul_f32 v[48:49], v[48:49], v[102:103] op_sel_hi:[1,0]
    v_pk_mul_f32 v[66:67], v[66:67], v[50:51]
    v_pk_mul_f32 v[50:51], v[50:51], v[102:103] op_sel_hi:[1,0]
    v_pk_mul_f32 v[72:73], v[72:73], v[56:57]
    v_pk_mul_f32 v[56:57], v[56:57], v[102:103] op_sel_hi:[1,0]
    v_pk_mul_f32 v[74:75], v[74:75], v[58:59]
    v_pk_mul_f32 v[58:59], v[58:59], v[102:103] op_sel_hi:[1,0]
    v_exp_f32 v48, v48
    v_exp_f32 v49, v49
    v_exp_f32 v50, v50
    v_exp_f32 v51, v51
    buffer_load_dwordx4 a[40:43], v9, s[40:43], s9 offen offset:0 sc1
    v_exp_f32 v56, v56
    v_exp_f32 v57, v57
    v_exp_f32 v58, v58
    v_exp_f32 v59, v59
    v_pk_fma_f32 v[48:49], v[48:49], v[102:103], v[102:103] op_sel:[0,1,1] op_sel_hi:[1,1,1]
    v_pk_fma_f32 v[50:51], v[50:51], v[102:103], v[102:103] op_sel:[0,1,1] op_sel_hi:[1,1,1]
    v_pk_fma_f32 v[56:57], v[56:57], v[102:103], v[102:103] op_sel:[0,1,1] op_sel_hi:[1,1,1]
    v_pk_fma_f32 v[58:59], v[58:59], v[102:103], v[102:103] op_sel:[0,1,1] op_sel_hi:[1,1,1]
    v_rcp_f32 v48, v48
    v_rcp_f32 v49, v49
    v_rcp_f32 v50, v50
    v_rcp_f32 v51, v51
    buffer_load_dwordx4 a[44:47], v9, s[40:43], s9 offen offset:2048 sc1
    v_rcp_f32 v56, v56
    v_rcp_f32 v57, v57
    v_rcp_f32 v58, v58
    v_rcp_f32 v59, v59
    v_pk_mul_f32 v[64:65], v[64:65], v[48:49]
    v_pk_mul_f32 v[66:67], v[66:67], v[50:51]
    v_pk_mul_f32 v[72:73], v[72:73], v[56:57]
    v_pk_mul_f32 v[74:75], v[74:75], v[58:59]
    v_cvt_pk_bf16_f32 v48, v64, v65
    v_cvt_pk_bf16_f32 v49, v66, v67
    v_cvt_pk_bf16_f32 v50, v72, v73
    v_cvt_pk_bf16_f32 v51, v74, v75
    s_add_u32 s27, s64, 688128
    buffer_store_dwordx4 v[48:51], v1, s[40:43], s27 offen offset:0 sc1
    v_pk_mul_f32 v[68:69], v[68:69], v[52:53]
    v_pk_mul_f32 v[52:53], v[52:53], v[102:103] op_sel_hi:[1,0]
    v_pk_mul_f32 v[70:71], v[70:71], v[54:55]
    v_pk_mul_f32 v[54:55], v[54:55], v[102:103] op_sel_hi:[1,0]
    v_pk_mul_f32 v[76:77], v[76:77], v[60:61]
    v_pk_mul_f32 v[60:61], v[60:61], v[102:103] op_sel_hi:[1,0]
    v_pk_mul_f32 v[78:79], v[78:79], v[62:63]
    v_pk_mul_f32 v[62:63], v[62:63], v[102:103] op_sel_hi:[1,0]
    v_exp_f32 v52, v52
    v_exp_f32 v53, v53
    v_exp_f32 v54, v54
    v_exp_f32 v55, v55
    v_exp_f32 v60, v60
    v_exp_f32 v61, v61
    v_exp_f32 v62, v62
    v_exp_f32 v63, v63
    v_pk_fma_f32 v[52:53], v[52:53], v[102:103], v[102:103] op_sel:[0,1,1] op_sel_hi:[1,1,1]
    v_pk_fma_f32 v[54:55], v[54:55], v[102:103], v[102:103] op_sel:[0,1,1] op_sel_hi:[1,1,1]
    v_pk_fma_f32 v[60:61], v[60:61], v[102:103], v[102:103] op_sel:[0,1,1] op_sel_hi:[1,1,1]
    v_pk_fma_f32 v[62:63], v[62:63], v[102:103], v[102:103] op_sel:[0,1,1] op_sel_hi:[1,1,1]
    v_rcp_f32 v52, v52
    v_rcp_f32 v53, v53
    v_rcp_f32 v54, v54
    v_rcp_f32 v55, v55
    v_rcp_f32 v60, v60
    v_rcp_f32 v61, v61
    v_rcp_f32 v62, v62
    v_rcp_f32 v63, v63
    v_pk_mul_f32 v[68:69], v[68:69], v[52:53]
    v_pk_mul_f32 v[70:71], v[70:71], v[54:55]
    v_pk_mul_f32 v[76:77], v[76:77], v[60:61]
    v_pk_mul_f32 v[78:79], v[78:79], v[62:63]
    v_cvt_pk_bf16_f32 v52, v68, v69
    v_cvt_pk_bf16_f32 v53, v70, v71
    v_cvt_pk_bf16_f32 v54, v76, v77
    v_cvt_pk_bf16_f32 v55, v78, v79
    buffer_store_dwordx4 v[52:55], v1, s[40:43], s27 offen offset:1024 sc1
    s_waitcnt vmcnt(12)
    s_nop 0
    v_mfma_f32_16x16x32_bf16 v[16:19], v[112:115], a[0:3], v[16:19]
    buffer_load_dwordx4 a[48:51], v9, s[40:43], s10 offen offset:0 sc1
    v_mfma_f32_16x16x32_bf16 v[20:23], v[116:119], a[0:3], 0
    ds_read_b64_tr_b16 a[146:147], v253 offset:6144
    ds_read_b64_tr_b16 a[150:151], v11 offset:6144
    v_mfma_f32_16x16x32_bf16 v[24:27], v[120:123], a[0:3], 0
    ds_read_b64_tr_b16 a[154:155], v15 offset:6144
    ds_read_b64_tr_b16 a[158:159], v14 offset:6144
    v_mfma_f32_16x16x32_bf16 v[28:31], v[124:127], a[0:3], 0
    v_mfma_f32_16x16x32_bf16 v[16:19], v[128:131], a[4:7], v[16:19]
    ds_read_b64_tr_b16 a[160:161], v253 offset:8192
    ds_read_b64_tr_b16 a[164:165], v11 offset:8192
    buffer_load_dwordx4 a[52:55], v9, s[40:43], s10 offen offset:2048 sc1
    v_mfma_f32_16x16x32_bf16 v[20:23], v[132:135], a[4:7], v[20:23]
    ds_read_b64_tr_b16 a[168:169], v15 offset:8192
    ds_read_b64_tr_b16 a[172:173], v14 offset:8192
    v_mfma_f32_16x16x32_bf16 v[24:27], v[136:139], a[4:7], v[24:27]
    v_mfma_f32_16x16x32_bf16 v[28:31], v[140:143], a[4:7], v[28:31]
    ds_read_b64_tr_b16 a[162:163], v253 offset:0
    ds_read_b64_tr_b16 a[166:167], v11 offset:0
    s_waitcnt vmcnt(12)
    s_nop 0
    v_mfma_f32_16x16x32_bf16 v[16:19], v[144:147], a[8:11], v[16:19]
    ds_read_b64_tr_b16 a[170:171], v15 offset:0
    ds_read_b64_tr_b16 a[174:175], v14 offset:0
    s_add_u32 s4, s4, 229376
    buffer_load_dwordx4 a[56:59], v9, s[40:43], s4 offen offset:0 sc1
    v_mfma_f32_16x16x32_bf16 v[20:23], v[148:151], a[8:11], v[20:23]
    v_mfma_f32_16x16x32_bf16 v[24:27], v[152:155], a[8:11], v[24:27]
    ds_read_b64_tr_b16 a[176:177], v253 offset:2048
    ds_read_b64_tr_b16 a[180:181], v11 offset:2048
    v_mfma_f32_16x16x32_bf16 v[28:31], v[156:159], a[8:11], v[28:31]
    ds_read_b64_tr_b16 a[184:185], v15 offset:2048
    ds_read_b64_tr_b16 a[188:189], v14 offset:2048
    v_mfma_f32_16x16x32_bf16 v[16:19], v[160:163], a[12:15], v[16:19]
    buffer_load_dwordx4 a[60:63], v9, s[40:43], s4 offen offset:2048 sc1
    v_mfma_f32_16x16x32_bf16 v[20:23], v[164:167], a[12:15], v[20:23]
    ds_read_b64_tr_b16 a[178:179], v253 offset:4096
    ds_read_b64_tr_b16 a[182:183], v11 offset:4096
    v_mfma_f32_16x16x32_bf16 v[24:27], v[168:171], a[12:15], v[24:27]
    ds_read_b64_tr_b16 a[186:187], v15 offset:4096
    ds_read_b64_tr_b16 a[190:191], v14 offset:4096
    v_mfma_f32_16x16x32_bf16 v[28:31], v[172:175], a[12:15], v[28:31]
    s_waitcnt vmcnt(12)
    s_nop 0
    v_mfma_f32_16x16x32_bf16 v[16:19], v[176:179], a[16:19], v[16:19]
    s_add_u32 s5, s5, 229376
    buffer_load_dwordx4 a[64:67], v9, s[40:43], s5 offen offset:0 sc1
    v_mfma_f32_16x16x32_bf16 v[20:23], v[180:183], a[16:19], v[20:23]
    v_mfma_f32_16x16x32_bf16 v[24:27], v[184:187], a[16:19], v[24:27]
    v_mfma_f32_16x16x32_bf16 v[28:31], v[188:191], a[16:19], v[28:31]
    v_mfma_f32_16x16x32_bf16 v[16:19], v[192:195], a[20:23], v[16:19]
    buffer_load_dwordx4 a[68:71], v9, s[40:43], s5 offen offset:2048 sc1
    v_mfma_f32_16x16x32_bf16 v[20:23], v[196:199], a[20:23], v[20:23]
    v_mfma_f32_16x16x32_bf16 v[24:27], v[200:203], a[20:23], v[24:27]
    v_mfma_f32_16x16x32_bf16 v[28:31], v[204:207], a[20:23], v[28:31]
    s_waitcnt vmcnt(12)
    v_mfma_f32_16x16x32_bf16 v[16:19], v[208:211], a[24:27], v[16:19]
    s_add_u32 s6, s6, 229376
    buffer_load_dwordx4 a[72:75], v9, s[40:43], s6 offen offset:0 sc1
    v_mfma_f32_16x16x32_bf16 v[20:23], v[212:215], a[24:27], v[20:23]
    v_mfma_f32_16x16x32_bf16 v[24:27], v[216:219], a[24:27], v[24:27]
    v_mfma_f32_16x16x32_bf16 v[28:31], v[220:223], a[24:27], v[28:31]
    s_cmp_lg_u32 s3, 0
    s_cbranch_scc1 L_w0_27
    s_atomic_umax s38, s[24:25], s87 offset:5120 glc
L_w0_27:
    v_mfma_f32_16x16x32_bf16 v[16:19], v[224:227], a[28:31], v[16:19]
    buffer_load_dwordx4 a[76:79], v9, s[40:43], s6 offen offset:2048 sc1
    v_mfma_f32_16x16x32_bf16 v[20:23], v[228:231], a[28:31], v[20:23]
    v_mfma_f32_16x16x32_bf16 v[24:27], v[232:235], a[28:31], v[24:27]
    v_mfma_f32_16x16x32_bf16 v[28:31], v[236:239], a[28:31], v[28:31]
    s_waitcnt vmcnt(12)
    v_mfma_f32_16x16x32_bf16 v[16:19], a[224:227], a[32:35], v[16:19]
    s_add_u32 s7, s7, 229376
    buffer_load_dwordx4 a[80:83], v9, s[40:43], s7 offen offset:0 sc1
    v_mfma_f32_16x16x32_bf16 v[20:23], a[228:231], a[32:35], v[20:23]
    v_mfma_f32_16x16x32_bf16 v[24:27], a[232:235], a[32:35], v[24:27]
    v_mfma_f32_16x16x32_bf16 v[28:31], a[236:239], a[32:35], v[28:31]
    v_mfma_f32_16x16x32_bf16 v[16:19], a[112:115], a[36:39], v[16:19]
    buffer_load_dwordx4 a[84:87], v9, s[40:43], s7 offen offset:2048 sc1
    v_mfma_f32_16x16x32_bf16 v[20:23], a[116:119], a[36:39], v[20:23]
    v_mfma_f32_16x16x32_bf16 v[24:27], a[120:123], a[36:39], v[24:27]
    v_mfma_f32_16x16x32_bf16 v[28:31], a[124:127], a[36:39], v[28:31]
    s_waitcnt vmcnt(12)
    v_mfma_f32_16x16x32_bf16 v[16:19], a[128:131], a[40:43], v[16:19]
    s_add_u32 s8, s8, 229376
    buffer_load_dwordx4 a[88:91], v9, s[40:43], s8 offen offset:0 sc1
L_pad6:
    s_cbranch_execz L_hopret
    v_mfma_f32_16x16x32_bf16 v[20:23], a[132:135], a[40:43], v[20:23]
    v_mfma_f32_16x16x32_bf16 v[24:27], a[136:139], a[40:43], v[24:27]
    v_mfma_f32_16x16x32_bf16 v[28:31], a[140:143], a[40:43], v[28:31]
    s_waitcnt lgkmcnt(15)
    v_mfma_f32_16x16x32_bf16 v[16:19], a[144:147], a[44:47], v[16:19]
    buffer_load_dwordx4 a[92:95], v9, s[40:43], s8 offen offset:2048 sc1
    v_mfma_f32_16x16x32_bf16 v[20:23], a[148:151], a[44:47], v[20:23]
    v_mfma_f32_16x16x32_bf16 v[24:27], a[152:155], a[44:47], v[24:27]
    v_mfma_f32_16x16x32_bf16 v[28:31], a[156:159], a[44:47], v[28:31]
    s_waitcnt vmcnt(10)
    s_waitcnt lgkmcnt(8)
    v_mfma_f32_16x16x32_bf16 v[16:19], a[160:163], a[48:51], v[16:19]
    s_add_u32 s9, s9, 229376
    buffer_load_dwordx4 a[96:99], v9, s[40:43], s9 offen offset:0 sc1
    v_mfma_f32_16x16x32_bf16 v[20:23], a[164:167], a[48:51], v[20:23]
    v_mfma_f32_16x16x32_bf16 v[24:27], a[168:171], a[48:51], v[24:27]
    v_mfma_f32_16x16x32_bf16 v[28:31], a[172:175], a[48:51], v[28:31]
    s_waitcnt lgkmcnt(0)
    v_mfma_f32_16x16x32_bf16 v[16:19], a[176:179], a[52:55], v[16:19]
    buffer_load_dwordx4 a[100:103], v9, s[40:43], s9 offen offset:2048 sc1
    v_mfma_f32_16x16x32_bf16 v[20:23], a[180:183], a[52:55], v[20:23]
    v_mfma_f32_16x16x32_bf16 v[24:27], a[184:187], a[52:55], v[24:27]
    v_mfma_f32_16x16x32_bf16 v[28:31], a[188:191], a[52:55], v[28:31]
    s_cmp_eq_u32 s3, 0
    s_cselect_b32 s39, s38, 14
    s_cmp_lt_u32 s39, 14
    s_cbranch_scc1 L_slow_28
L_back_29:
    s_barrier
    s_cmp_lg_u32 s3, 0
    s_cbranch_scc1 L_w0_30
    s_mov_b32 s88, 0
    s_mov_b32 s37, 0
    s_atomic_add s99, s[24:25], s87 offset:32768
    s_atomic_add s99, s[24:25], s87 offset:33792
    s_atomic_add s99, s[24:25], s87 offset:34816
    s_atomic_add s99, s[24:25], s87 offset:35840
L_w0_30:
    s_waitcnt vmcnt(10)
    v_mfma_f32_16x16x32_bf16 v[32:35], v[112:115], a[56:59], v[32:35]
    s_add_u32 s10, s10, 229376
    buffer_load_dwordx4 a[104:107], v9, s[40:43], s10 offen offset:0 sc1
    v_mfma_f32_16x16x32_bf16 v[36:39], v[116:119], a[56:59], 0
    v_lshlrev_b32 v48, 16, v108
    v_mfma_f32_16x16x32_bf16 v[40:43], v[120:123], a[56:59], 0
    v_and_b32 v49, 0xffff0000, v108
    v_lshlrev_b32 v50, 16, v109
    v_mfma_f32_16x16x32_bf16 v[44:47], v[124:127], a[56:59], 0
    v_and_b32 v51, 0xffff0000, v109
    v_mfma_f32_16x16x32_bf16 v[32:35], v[128:131], a[60:63], v[32:35]
    buffer_load_dwordx4 a[108:111], v9, s[40:43], s10 offen offset:2048 sc1
    v_lshlrev_b32 v64, 16, v110
    v_mfma_f32_16x16x32_bf16 v[36:39], v[132:135], a[60:63], v[36:39]
    v_and_b32 v65, 0xffff0000, v110
    v_lshlrev_b32 v66, 16, v111
    v_mfma_f32_16x16x32_bf16 v[40:43], v[136:139], a[60:63], v[40:43]
    v_and_b32 v67, 0xffff0000, v111
    v_mfma_f32_16x16x32_bf16 v[44:47], v[140:143], a[60:63], v[44:47]
    s_waitcnt vmcnt(10)
    s_nop 0
    v_mfma_f32_16x16x32_bf16 v[32:35], v[144:147], a[64:67], v[32:35]
    s_add_u32 s4, s4, 229376
    buffer_load_dwordx4 a[0:3], v9, s[40:43], s4 offen offset:0 sc1
    v_mfma_f32_16x16x32_bf16 v[36:39], v[148:151], a[64:67], v[36:39]
    ds_write_b128 v5, v[16:19] offset:0
    v_mfma_f32_16x16x32_bf16 v[40:43], v[152:155], a[64:67], v[40:43]
    v_mfma_f32_16x16x32_bf16 v[44:47], v[156:159], a[64:67], v[44:47]
    v_mfma_f32_16x16x32_bf16 v[32:35], v[160:163], a[68:71], v[32:35]
    buffer_load_dwordx4 a[4:7], v9, s[40:43], s4 offen offset:2048 sc1
    v_mfma_f32_16x16x32_bf16 v[36:39], v[164:167], a[68:71], v[36:39]
    ds_write_b128 v6, v[20:23] offset:0
    v_mfma_f32_16x16x32_bf16 v[40:43], v[168:171], a[68:71], v[40:43]
    v_mfma_f32_16x16x32_bf16 v[44:47], v[172:175], a[68:71], v[44:47]
    s_waitcnt vmcnt(10)
    s_nop 0
    v_mfma_f32_16x16x32_bf16 v[32:35], v[176:179], a[72:75], v[32:35]
    s_add_u32 s5, s5, 229376
    buffer_load_dwordx4 a[8:11], v9, s[40:43], s5 offen offset:0 sc1
    v_mfma_f32_16x16x32_bf16 v[36:39], v[180:183], a[72:75], v[36:39]
    ds_write_b128 v7, v[24:27] offset:0
    v_mfma_f32_16x16x32_bf16 v[40:43], v[184:187], a[72:75], v[40:43]
    v_mfma_f32_16x16x32_bf16 v[44:47], v[188:191], a[72:75], v[44:47]
    v_mfma_f32_16x16x32_bf16 v[32:35], v[192:195], a[76:79], v[32:35]
    buffer_load_dwordx4 a[12:15], v9, s[40:43], s5 offen offset:2048 sc1
    v_mfma_f32_16x16x32_bf16 v[36:39], v[196:199], a[76:79], v[36:39]
    ds_write_b128 v8, v[28:31] offset:0
    v_mfma_f32_16x16x32_bf16 v[40:43], v[200:203], a[76:79], v[40:43]
    v_mfma_f32_16x16x32_bf16 v[44:47], v[204:207], a[76:79], v[44:47]
    s_waitcnt vmcnt(10)
    s_nop 0
    v_mfma_f32_16x16x32_bf16 v[32:35], v[208:211], a[80:83], v[32:35]
    s_add_u32 s6, s6, 229376
    buffer_load_dwordx4 a[16:19], v9, s[40:43], s6 offen offset:0 sc1
    v_mfma_f32_16x16x32_bf16 v[36:39], v[212:215], a[80:83], v[36:39]
    v_mfma_f32_16x16x32_bf16 v[40:43], v[216:219], a[80:83], v[40:43]
    v_mfma_f32_16x16x32_bf16 v[44:47], v[220:223], a[80:83], v[44:47]
    v_mfma_f32_16x16x32_bf16 v[32:35], v[224:227], a[84:87], v[32:35]
    buffer_load_dwordx4 a[20:23], v9, s[40:43], s6 offen offset:2048 sc1
    v_mfma_f32_16x16x32_bf16 v[36:39], v[228:231], a[84:87], v[36:39]
    v_mfma_f32_16x16x32_bf16 v[40:43], v[232:235], a[84:87], v[40:43]
    v_mfma_f32_16x16x32_bf16 v[44:47], v[236:239], a[84:87], v[44:47]
    s_cmp_lg_u32 s3, 0
    s_cbranch_scc1 L_w0_31
    s_and_b32 s36, s79, 3
    s_lshl_b32 s36, s36, 10
    s_add_u32 s36, s36, s87
    s_atomic_umax s88, s[24:25], s36 offset:32768 glc
L_w0_31:
    s_waitcnt vmcnt(10)
    v_mfma_f32_16x16x32_bf16 v[32:35], a[224:227], a[88:91], v[32:35]
    s_add_u32 s7, s7, 229376
    buffer_load_dwordx4 a[24:27], v9, s[40:43], s7 offen offset:0 sc1
    v_mfma_f32_16x16x32_bf16 v[36:39], a[228:231], a[88:91], v[36:39]
    v_mfma_f32_16x16x32_bf16 v[40:43], a[232:235], a[88:91], v[40:43]
    v_mfma_f32_16x16x32_bf16 v[44:47], a[236:239], a[88:91], v[44:47]
    v_mfma_f32_16x16x32_bf16 v[32:35], a[112:115], a[92:95], v[32:35]
    buffer_load_dwordx4 a[28:31], v9, s[40:43], s7 offen offset:2048 sc1
    v_mfma_f32_16x16x32_bf16 v[36:39], a[116:119], a[92:95], v[36:39]
    v_mfma_f32_16x16x32_bf16 v[40:43], a[120:123], a[92:95], v[40:43]
    v_mfma_f32_16x16x32_bf16 v[44:47], a[124:127], a[92:95], v[44:47]
    s_waitcnt vmcnt(10)
    s_nop 0
    v_mfma_f32_16x16x32_bf16 v[32:35], a[128:131], a[96:99], v[32:35]
    s_add_u32 s8, s8, 229376
    buffer_load_dwordx4 a[32:35], v9, s[40:43], s8 offen offset:0 sc1
    v_mfma_f32_16x16x32_bf16 v[36:39], a[132:135], a[96:99], v[36:39]
    v_mfma_f32_16x16x32_bf16 v[40:43], a[136:139], a[96:99], v[40:43]
    v_mfma_f32_16x16x32_bf16 v[44:47], a[140:143], a[96:99], v[44:47]
    v_mfma_f32_16x16x32_bf16 v[32:35], a[144:147], a[100:103], v[32:35]
    buffer_load_dwordx4 a[36:39], v9, s[40:43], s8 offen offset:2048 sc1
    v_mfma_f32_16x16x32_bf16 v[36:39], a[148:151], a[100:103], v[36:39]
    v_mfma_f32_16x16x32_bf16 v[40:43], a[152:155], a[100:103], v[40:43]
    v_mfma_f32_16x16x32_bf16 v[44:47], a[156:159], a[100:103], v[44:47]
    s_waitcnt vmcnt(10)
    s_nop 0
    v_mfma_f32_16x16x32_bf16 v[32:35], a[160:163], a[104:107], v[32:35]
    s_add_u32 s9, s9, 229376
    buffer_load_dwordx4 a[40:43], v9, s[40:43], s9 offen offset:0 sc1
    v_mfma_f32_16x16x32_bf16 v[36:39], a[164:167], a[104:107], v[36:39]
    v_mfma_f32_16x16x32_bf16 v[40:43], a[168:171], a[104:107], v[40:43]
    v_mfma_f32_16x16x32_bf16 v[44:47], a[172:175], a[104:107], v[44:47]
    v_mfma_f32_16x16x32_bf16 v[32:35], a[176:179], a[108:111], v[32:35]
    buffer_load_dwordx4 a[44:47], v9, s[40:43], s9 offen offset:2048 sc1
    v_mfma_f32_16x16x32_bf16 v[36:39], a[180:183], a[108:111], v[36:39]
    v_mfma_f32_16x16x32_bf16 v[40:43], a[184:187], a[108:111], v[40:43]
    v_mfma_f32_16x16x32_bf16 v[44:47], a[188:191], a[108:111], v[44:47]
    s_waitcnt lgkmcnt(0)
    s_cmp_lg_u32 s3, 0
    s_cbranch_scc1 L_w0_34
    s_mov_b32 s89, 0
L_poll_32:
    s_waitcnt lgkmcnt(0)
    s_cmp_ge_u32 s88, 14
    s_cbranch_scc1 L_done_33
    s_atomic_umax s88, s[24:25], s36 offset:32768 glc
    s_add_u32 s89, s89, 1
    s_cmp_lt_u32 s89, 131072
    s_cbranch_scc1 L_poll_32
L_done_33:
L_w0_34:
    s_barrier
    s_waitcnt vmcnt(10)
    s_nop 0
    v_mfma_f32_16x16x32_bf16 v[48:51], v[112:115], a[0:3], v[48:51]
    s_add_u32 s10, s10, 229376
    buffer_load_dwordx4 a[48:51], v9, s[40:43], s10 offen offset:0 sc1
    v_mfma_f32_16x16x32_bf16 v[52:55], v[116:119], a[0:3], 0
    v_mfma_f32_16x16x32_bf16 v[56:59], v[120:123], a[0:3], 0
    ds_read_b128 v[16:19], v12 offset:0
    v_mfma_f32_16x16x32_bf16 v[60:63], v[124:127], a[0:3], 0
    v_mfma_f32_16x16x32_bf16 v[48:51], v[128:131], a[4:7], v[48:51]
    buffer_load_dwordx4 a[52:55], v9, s[40:43], s10 offen offset:2048 sc1
    v_mfma_f32_16x16x32_bf16 v[52:55], v[132:135], a[4:7], v[52:55]
    v_mfma_f32_16x16x32_bf16 v[56:59], v[136:139], a[4:7], v[56:59]
    ds_read_b128 v[20:23], v12 offset:4096
    v_mfma_f32_16x16x32_bf16 v[60:63], v[140:143], a[4:7], v[60:63]
    s_waitcnt vmcnt(10)
    s_nop 0
    v_mfma_f32_16x16x32_bf16 v[48:51], v[144:147], a[8:11], v[48:51]
    s_add_u32 s4, s4, 229376
    buffer_load_dwordx4 a[56:59], v9, s[40:43], s4 offen offset:0 sc1
    v_mfma_f32_16x16x32_bf16 v[52:55], v[148:151], a[8:11], v[52:55]
    v_mfma_f32_16x16x32_bf16 v[56:59], v[152:155], a[8:11], v[56:59]
    ds_read_b128 v[24:27], v12 offset:8192
    v_mfma_f32_16x16x32_bf16 v[60:63], v[156:159], a[8:11], v[60:63]
    v_mfma_f32_16x16x32_bf16 v[48:51], v[160:163], a[12:15], v[48:51]
    buffer_load_dwordx4 a[60:63], v9, s[40:43], s4 offen offset:2048 sc1
    v_mfma_f32_16x16x32_bf16 v[52:55], v[164:167], a[12:15], v[52:55]
    v_mfma_f32_16x16x32_bf16 v[56:59], v[168:171], a[12:15], v[56:59]
    ds_read_b128 v[28:31], v12 offset:12288
    v_mfma_f32_16x16x32_bf16 v[60:63], v[172:175], a[12:15], v[60:63]
    s_waitcnt vmcnt(10)
    s_nop 0
    v_mfma_f32_16x16x32_bf16 v[48:51], v[176:179], a[16:19], v[48:51]
    s_add_u32 s5, s5, 229376
    buffer_load_dwordx4 a[64:67], v9, s[40:43], s5 offen offset:0 sc1
    v_mfma_f32_16x16x32_bf16 v[52:55], v[180:183], a[16:19], v[52:55]
    ds_write_b128 v5, v[32:35] offset:16384
    v_mfma_f32_16x16x32_bf16 v[56:59], v[184:187], a[16:19], v[56:59]
    v_mfma_f32_16x16x32_bf16 v[60:63], v[188:191], a[16:19], v[60:63]
    v_mfma_f32_16x16x32_bf16 v[48:51], v[192:195], a[20:23], v[48:51]
    buffer_load_dwordx4 a[68:71], v9, s[40:43], s5 offen offset:2048 sc1
    v_mfma_f32_16x16x32_bf16 v[52:55], v[196:199], a[20:23], v[52:55]
    ds_write_b128 v6, v[36:39] offset:16384
    v_mfma_f32_16x16x32_bf16 v[56:59], v[200:203], a[20:23], v[56:59]
    v_mfma_f32_16x16x32_bf16 v[60:63], v[204:207], a[20:23], v[60:63]
    s_waitcnt vmcnt(10)
    s_nop 0
    v_mfma_f32_16x16x32_bf16 v[48:51], v[208:211], a[24:27], v[48:51]
    s_add_u32 s6, s6, 229376
    buffer_load_dwordx4 a[72:75], v9, s[40:43], s6 offen offset:0 sc1
    v_mfma_f32_16x16x32_bf16 v[52:55], v[212:215], a[24:27], v[52:55]
    ds_write_b128 v7, v[40:43] offset:16384
    v_mfma_f32_16x16x32_bf16 v[56:59], v[216:219], a[24:27], v[56:59]
    v_mfma_f32_16x16x32_bf16 v[60:63], v[220:223], a[24:27], v[60:63]
    v_mfma_f32_16x16x32_bf16 v[48:51], v[224:227], a[28:31], v[48:51]
    buffer_load_dwordx4 a[76:79], v9, s[40:43], s6 offen offset:2048 sc1
    v_mfma_f32_16x16x32_bf16 v[52:55], v[228:231], a[28:31], v[52:55]
    ds_write_b128 v8, v[44:47] offset:16384
    v_mfma_f32_16x16x32_bf16 v[56:59], v[232:235], a[28:31], v[56:59]
    v_mfma_f32_16x16x32_bf16 v[60:63], v[236:239], a[28:31], v[60:63]
    s_waitcnt vmcnt(10)
    s_nop 0
    v_mfma_f32_16x16x32_bf16 v[48:51], a[224:227], a[32:35], v[48:51]
    s_add_u32 s7, s7, 229376
    buffer_load_dwordx4 a[80:83], v9, s[40:43], s7 offen offset:0 sc1
    v_mfma_f32_16x16x32_bf16 v[52:55], a[228:231], a[32:35], v[52:55]
    v_mfma_f32_16x16x32_bf16 v[56:59], a[232:235], a[32:35], v[56:59]
    v_mfma_f32_16x16x32_bf16 v[60:63], a[236:239], a[32:35], v[60:63]
    v_mfma_f32_16x16x32_bf16 v[48:51], a[112:115], a[36:39], v[48:51]
    buffer_load_dwordx4 a[84:87], v9, s[40:43], s7 offen offset:2048 sc1
    v_mfma_f32_16x16x32_bf16 v[52:55], a[116:119], a[36:39], v[52:55]
    v_mfma_f32_16x16x32_bf16 v[56:59], a[120:123], a[36:39], v[56:59]
    v_mfma_f32_16x16x32_bf16 v[60:63], a[124:127], a[36:39], v[60:63]
    s_waitcnt vmcnt(10)
    v_mfma_f32_16x16x32_bf16 v[48:51], a[128:131], a[40:43], v[48:51]
    s_add_u32 s8, s8, 229376
    buffer_load_dwordx4 a[88:91], v9, s[40:43], s8 offen offset:0 sc1
    v_mfma_f32_16x16x32_bf16 v[52:55], a[132:135], a[40:43], v[52:55]
    s_waitcnt lgkmcnt(0)
    s_barrier
    v_mfma_f32_16x16x32_bf16 v[56:59], a[136:139], a[40:43], v[56:59]
    ds_read_b128 v[32:35], v12 offset:16384
    v_mfma_f32_16x16x32_bf16 v[60:63], a[140:143], a[40:43], v[60:63]
    v_mfma_f32_16x16x32_bf16 v[48:51], a[144:147], a[44:47], v[48:51]
    ds_read_b128 v[36:39], v12 offset:20480
    buffer_load_dwordx4 a[92:95], v9, s[40:43], s8 offen offset:2048 sc1
    v_mfma_f32_16x16x32_bf16 v[52:55], a[148:151], a[44:47], v[52:55]
    v_add_f32 v16, v16, v20
    v_mfma_f32_16x16x32_bf16 v[56:59], a[152:155], a[44:47], v[56:59]
    ds_read_b128 v[40:43], v12 offset:24576
    v_add_f32 v17, v17, v21
    v_mfma_f32_16x16x32_bf16 v[60:63], a[156:159], a[44:47], v[60:63]
    v_add_f32 v18, v18, v22
    s_waitcnt vmcnt(10)
    v_mfma_f32_16x16x32_bf16 v[48:51], a[160:163], a[48:51], v[48:51]
    ds_read_b128 v[44:47], v12 offset:28672
    s_add_u32 s9, s9, 229376
    buffer_load_dwordx4 a[96:99], v9, s[40:43], s9 offen offset:0 sc1
    v_mfma_f32_16x16x32_bf16 v[52:55], a[164:167], a[48:51], v[52:55]
    v_add_f32 v19, v19, v23
    v_mfma_f32_16x16x32_bf16 v[56:59], a[168:171], a[48:51], v[56:59]
    v_add_f32 v16, v16, v24
    v_add_f32 v17, v17, v25
    v_mfma_f32_16x16x32_bf16 v[60:63], a[172:175], a[48:51], v[60:63]
    v_add_f32 v18, v18, v26
    v_add_f32 v19, v19, v27
    v_mfma_f32_16x16x32_bf16 v[48:51], a[176:179], a[52:55], v[48:51]
    buffer_load_dwordx4 a[100:103], v9, s[40:43], s9 offen offset:2048 sc1
    v_mfma_f32_16x16x32_bf16 v[52:55], a[180:183], a[52:55], v[52:55]
    v_add_f32 v16, v16, v28
    v_add_f32 v17, v17, v29
    v_mfma_f32_16x16x32_bf16 v[56:59], a[184:187], a[52:55], v[56:59]
    v_add_f32 v18, v18, v30
    v_add_f32 v19, v19, v31
    v_mfma_f32_16x16x32_bf16 v[60:63], a[188:191], a[52:55], v[60:63]
    v_cvt_pk_bf16_f32 v80, v16, v17
    s_waitcnt vmcnt(10)
    v_mfma_f32_16x16x32_bf16 v[64:67], v[112:115], a[56:59], v[64:67]
    s_add_u32 s10, s10, 229376
    buffer_load_dwordx4 a[104:107], v9, s[40:43], s10 offen offset:0 sc1
    v_mfma_f32_16x16x32_bf16 v[68:71], v[116:119], a[56:59], 0
    v_cvt_pk_bf16_f32 v81, v18, v19
    s_waitcnt lgkmcnt(2)
    v_mfma_f32_16x16x32_bf16 v[72:75], v[120:123], a[56:59], 0
    v_add_f32 v32, v32, v36
    v_add_f32 v33, v33, v37
    v_mfma_f32_16x16x32_bf16 v[76:79], v[124:127], a[56:59], 0
    v_add_f32 v34, v34, v38
    v_add_f32 v35, v35, v39
    v_mfma_f32_16x16x32_bf16 v[64:67], v[128:131], a[60:63], v[64:67]
    buffer_load_dwordx4 a[108:111], v9, s[40:43], s10 offen offset:2048 sc1
    s_waitcnt lgkmcnt(1)
    v_mfma_f32_16x16x32_bf16 v[68:71], v[132:135], a[60:63], v[68:71]
    ds_write_b128 v5, v[48:51] offset:32768
    v_mfma_f32_16x16x32_bf16 v[72:75], v[136:139], a[60:63], v[72:75]
    v_add_f32 v32, v32, v40
    v_add_f32 v33, v33, v41
    v_mfma_f32_16x16x32_bf16 v[76:79], v[140:143], a[60:63], v[76:79]
    v_add_f32 v34, v34, v42
    s_waitcnt vmcnt(10)
    v_mfma_f32_16x16x32_bf16 v[64:67], v[144:147], a[64:67], v[64:67]
    v_add_f32 v35, v35, v43
    s_waitcnt lgkmcnt(1)
    v_mfma_f32_16x16x32_bf16 v[68:71], v[148:151], a[64:67], v[68:71]
    ds_write_b128 v6, v[52:55] offset:32768
    v_mfma_f32_16x16x32_bf16 v[72:75], v[152:155], a[64:67], v[72:75]
    v_add_f32 v32, v32, v44
    v_add_f32 v33, v33, v45
    v_mfma_f32_16x16x32_bf16 v[76:79], v[156:159], a[64:67], v[76:79]
    v_add_f32 v34, v34, v46
    v_add_f32_e64 v35, v35, v47
    v_mfma_f32_16x16x32_bf16 v[64:67], v[160:163], a[68:71], v[64:67]
    v_cvt_pk_bf16_f32 v82, v32, v33
    v_cvt_pk_bf16_f32 v83, v34, v35
    v_mfma_f32_16x16x32_bf16 v[68:71], v[164:167], a[68:71], v[68:71]
    ds_write_b128 v7, v[56:59] offset:32768
    v_mfma_f32_16x16x32_bf16 v[72:75], v[168:171], a[68:71], v[72:75]
    v_permlane16_swap_b32 v80, v82
    v_mfma_f32_16x16x32_bf16 v[76:79], v[172:175], a[68:71], v[76:79]
    s_waitcnt vmcnt(8)
    v_mfma_f32_16x16x32_bf16 v[64:67], v[176:179], a[72:75], v[64:67]
    v_permlane16_swap_b32 v81, v83
    v_mfma_f32_16x16x32_bf16 v[68:71], v[180:183], a[72:75], v[68:71]
    ds_write_b128 v8, v[60:63] offset:32768
    v_mfma_f32_16x16x32_bf16 v[72:75], v[184:187], a[72:75], v[72:75]
    v_mfma_f32_16x16x32_bf16 v[76:79], v[188:191], a[72:75], v[76:79]
    v_mfma_f32_16x16x32_bf16 v[64:67], v[192:195], a[76:79], v[64:67]
    v_mfma_f32_16x16x32_bf16 v[68:71], v[196:199], a[76:79], v[68:71]
    v_mfma_f32_16x16x32_bf16 v[72:75], v[200:203], a[76:79], v[72:75]
    v_mfma_f32_16x16x32_bf16 v[76:79], v[204:207], a[76:79], v[76:79]
    s_waitcnt vmcnt(6)
    v_mfma_f32_16x16x32_bf16 v[64:67], v[208:211], a[80:83], v[64:67]
    v_mfma_f32_16x16x32_bf16 v[68:71], v[212:215], a[80:83], v[68:71]
    s_waitcnt lgkmcnt(0)
    s_barrier
    v_mfma_f32_16x16x32_bf16 v[72:75], v[216:219], a[80:83], v[72:75]
    ds_read_b128 v[48:51], v12 offset:32768
    v_mfma_f32_16x16x32_bf16 v[76:79], v[220:223], a[80:83], v[76:79]
    ds_read_b128 v[52:55], v12 offset:36864
    v_mfma_f32_16x16x32_bf16 v[64:67], v[224:227], a[84:87], v[64:67]
    ds_read_b128 v[56:59], v12 offset:40960
    v_mfma_f32_16x16x32_bf16 v[68:71], v[228:231], a[84:87], v[68:71]
    ds_read_b128 v[60:63], v12 offset:45056
    v_mfma_f32_16x16x32_bf16 v[72:75], v[232:235], a[84:87], v[72:75]
    v_mfma_f32_16x16x32_bf16 v[76:79], v[236:239], a[84:87], v[76:79]
    s_waitcnt vmcnt(4)
    s_nop 0
    v_mfma_f32_16x16x32_bf16 v[64:67], a[224:227], a[88:91], v[64:67]
    v_mfma_f32_16x16x32_bf16 v[68:71], a[228:231], a[88:91], v[68:71]
    v_mfma_f32_16x16x32_bf16 v[72:75], a[232:235], a[88:91], v[72:75]
    v_mfma_f32_16x16x32_bf16 v[76:79], a[236:239], a[88:91], v[76:79]
    v_mfma_f32_16x16x32_bf16 v[64:67], a[112:115], a[92:95], v[64:67]
    v_mfma_f32_16x16x32_bf16 v[68:71], a[116:119], a[92:95], v[68:71]
    v_mfma_f32_16x16x32_bf16 v[72:75], a[120:123], a[92:95], v[72:75]
    v_mfma_f32_16x16x32_bf16 v[76:79], a[124:127], a[92:95], v[76:79]
    buffer_store_dwordx4 v[80:83], v4, s[28:31], s68 offen sc1
    s_waitcnt vmcnt(4)
    v_mfma_f32_16x16x32_bf16 v[64:67], a[128:131], a[96:99], v[64:67]
    s_waitcnt lgkmcnt(2)
    s_waitcnt vmcnt(3)
    v_mfma_f32_16x16x32_bf16 v[64:67], a[144:147], a[100:103], v[64:67]
    v_add_f32 v48, v48, v52
    s_waitcnt vmcnt(2)
    v_mfma_f32_16x16x32_bf16 v[64:67], a[160:163], a[104:107], v[64:67]
    v_add_f32 v49, v49, v53
    s_waitcnt vmcnt(1)
    v_mfma_f32_16x16x32_bf16 v[64:67], a[176:179], a[108:111], v[64:67]
    v_add_f32 v50, v50, v54
    v_add_f32 v51, v51, v55
    v_mfma_f32_16x16x32_bf16 v[68:71], a[132:135], a[96:99], v[68:71]
    s_waitcnt lgkmcnt(1)
    v_add_f32 v48, v48, v56
    v_mfma_f32_16x16x32_bf16 v[68:71], a[148:151], a[100:103], v[68:71]
    v_add_f32 v49, v49, v57
    v_add_f32 v50, v50, v58
    v_mfma_f32_16x16x32_bf16 v[68:71], a[164:167], a[104:107], v[68:71]
    v_add_f32 v51, v51, v59
    s_waitcnt lgkmcnt(0)
    v_mfma_f32_16x16x32_bf16 v[68:71], a[180:183], a[108:111], v[68:71]
    ds_write_b128 v5, v[64:67] offset:0
    v_mfma_f32_16x16x32_bf16 v[72:75], a[136:139], a[96:99], v[72:75]
    v_add_f32 v48, v48, v60
    v_add_f32 v49, v49, v61
    v_mfma_f32_16x16x32_bf16 v[72:75], a[152:155], a[100:103], v[72:75]
    v_add_f32 v50, v50, v62
    v_add_f32_e64 v51, v51, v63
    v_mfma_f32_16x16x32_bf16 v[72:75], a[168:171], a[104:107], v[72:75]
    v_cvt_pk_bf16_f32 v84, v48, v49
    v_cvt_pk_bf16_f32 v85, v50, v51
    v_mfma_f32_16x16x32_bf16 v[72:75], a[184:187], a[108:111], v[72:75]
    ds_write_b128 v6, v[68:71] offset:0
    v_mfma_f32_16x16x32_bf16 v[76:79], a[140:143], a[96:99], v[76:79]
    v_mfma_f32_16x16x32_bf16 v[76:79], a[156:159], a[100:103], v[76:79]
    v_mfma_f32_16x16x32_bf16 v[76:79], a[172:175], a[104:107], v[76:79]
    v_mfma_f32_16x16x32_bf16 v[76:79], a[188:191], a[108:111], v[76:79]
    s_nop 2
    ds_write_b128 v7, v[72:75] offset:0
    s_nop 3
    ds_write_b128 v8, v[76:79] offset:0
    s_waitcnt lgkmcnt(0)
    s_barrier
    ds_read_b128 v[64:67], v12 offset:0
    ds_read_b128 v[68:71], v12 offset:4096
    ds_read_b128 v[72:75], v12 offset:8192
    ds_read_b128 v[76:79], v12 offset:12288
    s_waitcnt lgkmcnt(2)
    v_pk_add_f32 v[64:65], v[64:65], v[68:69]
    v_pk_add_f32 v[66:67], v[66:67], v[70:71]
    s_waitcnt lgkmcnt(1)
    v_pk_add_f32 v[64:65], v[64:65], v[72:73]
    v_pk_add_f32 v[66:67], v[66:67], v[74:75]
    s_waitcnt lgkmcnt(0)
    v_pk_add_f32 v[64:65], v[64:65], v[76:77]
    v_pk_add_f32 v[66:67], v[66:67], v[78:79]
    v_cvt_pk_bf16_f32 v86, v64, v65
    v_cvt_pk_bf16_f32 v87, v66, v67
    s_nop 0
    v_permlane16_swap_b32 v84, v86
    v_permlane16_swap_b32 v85, v87
    s_add_u32 s68, s68, 57344
    buffer_store_dwordx4 v[84:87], v4, s[28:31], s68 offen sc1
    s_endpgm
L_slow_5:
    s_mov_b32 s89, 0
L_slow_5_l:
    global_load_dword v15, v243, s[22:23] sc1
    s_add_u32 s89, s89, 1
    s_waitcnt vmcnt(0)
    v_readfirstlane_b32 s88, v15
    s_nop 0
    s_and_b32 s12, s88, 0xffff
    s_cmp_ge_u32 s12, 49
    s_cbranch_scc1 L_back_6
    s_cmp_lt_u32 s89, 131072
    s_cbranch_scc1 L_slow_5_l
    s_branch L_back_6
L_slow_24:
    s_mov_b32 s89, 0
L_slow_24_l:
    s_waitcnt lgkmcnt(0)
    s_cmp_ge_u32 s38, 14
    s_cbranch_scc1 L_back_25
    s_atomic_umax s38, s[24:25], s87 offset:4096 glc
    s_add_u32 s89, s89, 1
    s_cmp_lt_u32 s89, 131072
    s_cbranch_scc1 L_slow_24_l
    s_branch L_back_25
L_slow_28:
    s_mov_b32 s89, 0
L_slow_28_l:
    s_waitcnt lgkmcnt(0)
    s_cmp_ge_u32 s38, 14
    s_cbranch_scc1 L_back_29
    s_atomic_umax s38, s[24:25], s87 offset:5120 glc
    s_add_u32 s89, s89, 1
    s_cmp_lt_u32 s89, 131072
    s_cbranch_scc1 L_slow_28_l
    s_branch L_back_29
L_idle:
    s_mov_b64 s[32:33], s[18:19]
    s_mov_b32 s34, 1605632
    s_mov_b32 s35, 0x20000
    s_lshr_b32 s26, s73, 1
    s_lshl_b32 s26, s26, 2
    s_add_u32 s26, s26, s3
    s_mul_i32 s26, s26, 12544
    v_min_u32 v2, 48, v0
    v_lshlrev_b32 v2, 8, v2
    buffer_load_dword v3, v2, s[32:35], s26 offen
    buffer_load_dword v4, v2, s[32:35], s26 offen offset:128
L_end:
    s_endpgm
.section .rodata,"a"
.p2align 6
.amdhsa_kernel sequential_preLN__linear_kernel_hedgehog__swiglu_ffn__prompt_kernel
  .amdhsa_next_free_vgpr 512
  .amdhsa_next_free_sgpr 102
  .amdhsa_accum_offset 256
  .amdhsa_group_segment_fixed_size 0
  .amdhsa_kernarg_size 88
  .amdhsa_user_sgpr_count 2
  .amdhsa_user_sgpr_kernarg_segment_ptr 1
  .amdhsa_system_sgpr_workgroup_id_x 1
.end_amdhsa_kernel
```
